```python
import torch

def _softmax(x, axis=-1):
    return torch.softmax(x, dim=axis)
def _gelu(x):
    return torch.nn.functional.gelu(x, approximate="tanh")
def _silu(x):
    return torch.nn.functional.silu(x)
def _sigmoid(x):
    return torch.sigmoid(x)
def _layernorm(x, axis=-1, eps=1e-5):
    m = x.mean(dim=axis, keepdim=True)
    v = x.var(dim=axis, keepdim=True, unbiased=False)
    return (x - m) / torch.sqrt(v + eps)
def _scatter_add(tgt, idx, src, axis=0):
    return tgt.clone().index_add_(axis, idx, src)
def _segment_sum(src, seg, n):
    out = torch.zeros((n,) + src.shape[1:], dtype=src.dtype)
    return out.index_add_(0, seg, src)
def _pad(x, pw):
    flat = tuple(v for pair in reversed(pw) for v in pair)
    return torch.nn.functional.pad(x, flat)

kernel_name = 'sequential_preLN__sliding_local_dilated__glu_gated_reglu__prompt'

def setup_inputs():

    _w = (lambda a: (lambda t: t.to(torch.bfloat16) if t.is_floating_point() else t)(torch.as_tensor(a)))
    def _A_setup():
        B, S, D = 1, 2048, 512
        return {
            "x": _w((lambda *s: torch.randn(*s, dtype=torch.bfloat16) * 0.05)(B, S, D)),
            "wqkv": _w((lambda *s: torch.randn(*s, dtype=torch.bfloat16) * 0.05)(D, 3 * D)),
            "wo": _w((lambda *s: torch.randn(*s, dtype=torch.bfloat16) * 0.05)(D, D)),
        }
    _A_in = _A_setup()

    def _B_setup():
        B, S, D, F = 1, 2048, 512, 1376
        return {
            "x": _w((lambda *s: torch.randn(*s, dtype=torch.bfloat16) * 0.05)(B, S, D)),
            "W_gate": _w((lambda *s: torch.randn(*s, dtype=torch.bfloat16) * 0.8)(D, F) * (2.0 / D) ** 0.5),
            "W_up": _w((lambda *s: torch.randn(*s, dtype=torch.bfloat16) * 0.8)(D, F) * (2.0 / D) ** 0.5),
            "W_down": _w((lambda *s: torch.randn(*s, dtype=torch.bfloat16) * 0.8)(F, D) * (1.0 / F) ** 0.5),
        }
    _B_in = _B_setup()

    return {
        "A_x": _A_in["x"],
        "A_wqkv": _A_in["wqkv"],
        "A_wo": _A_in["wo"],
        "B_x": _B_in["x"],
        "B_W_gate": _B_in["W_gate"],
        "B_W_up": _B_in["W_up"],
        "B_W_down": _B_in["W_down"],
    }

def reference(A_x, A_wqkv, A_wo, B_x, B_W_gate, B_W_up, B_W_down):
    def _A_ref(x, wqkv, wo):
        B, S, D = x.shape
        H = 32; Dh = D // H
        W, dil = 8, 2
        qkv = (lambda x, *d: x.permute(*d))((x @ wqkv).reshape(B, S, 3, H, Dh), 2, 0, 3, 1, 4)
        q, k, v = qkv[0], qkv[1], qkv[2]
        scale = Dh ** -0.5
        pos = torch.arange(S)
        off = torch.arange(W) * dil
        idx = pos[:, None] - off[None, :]
        mask = idx >= 0
        idx_c = torch.where(mask, idx, 0).reshape(-1)
        kg = k[:, :, idx_c, :].reshape(B, H, S, W, Dh)
        vg = v[:, :, idx_c, :].reshape(B, H, S, W, Dh)
        logits = torch.einsum("bhsd,bhswd->bhsw", q, kg) * scale
        logits = torch.where(mask[None, None, :, :], logits, -1e9)
        attn = _softmax(logits, axis=-1)
        o = torch.einsum("bhsw,bhswd->bhsd", attn, vg)
        return (lambda x, *d: x.permute(*d))(o, 0, 2, 1, 3).reshape(B, S, D) @ wo

    def _B_ref(x, W_gate, W_up, W_down):
        gate = torch.einsum("bsd,df->bsf", x, W_gate)
        up = torch.einsum("bsd,df->bsf", x, W_up)
        gate = gate * (lambda x, dt: x.to(dt))(gate > 0, gate.dtype)
        h = gate * up
        return torch.einsum("bsf,fd->bsd", h, W_down)

    x = A_x
    h = x + _A_ref(_layernorm(x, axis=-1), A_wqkv, A_wo)
    h2 = h + _B_ref(_layernorm(h, axis=-1), B_W_gate, B_W_up, B_W_down)
    return h2
```

```asm
; @launch grid=(256,1,1) block=(256,1,1) lds=163840
.amdgcn_target "amdgcn-amd-amdhsa--gfx950"
.text
.p2align 8
.globl sequential_preLN__sliding_local_dilated__glu_gated_reglu__prompt_kernel
.type sequential_preLN__sliding_local_dilated__glu_gated_reglu__prompt_kernel,@function
sequential_preLN__sliding_local_dilated__glu_gated_reglu__prompt_kernel:
    s_cmp_ge_u32 s2, 256
    s_cbranch_scc1 L_done
    s_load_dwordx16 s[44:59], s[0:1], 0
    s_load_dwordx4 s[60:63], s[0:1], 64
    s_getpc_b64 s[84:85]
L_pc:
    s_lshr_b32 s86, s2, 3
    s_lshl_b32 s86, s86, 10
    v_lshrrev_b32 v11, 5, v0
    v_lshlrev_b32 v11, 7, v11
    v_add_u32 v11, s86, v11
    v_min_u32 v11, L_done-L_pc, v11
    global_load_dword v6, v11, s[84:85]
    v_and_b32 v1, 63, v0
    v_lshrrev_b32 v8, 6, v0
    s_lshr_b32 s70, s2, 3
    s_and_b32 s65, s2, 7
    s_lshl_b32 s65, s65, 1
    v_readfirstlane_b32 s64, v8
    s_lshr_b32 s71, s70, 4
    s_add_u32 s65, s65, s71
    s_and_b32 s66, s70, 15
    s_lshr_b32 s67, s66, 3
    s_and_b32 s68, s66, 7
    s_lshl_b32 s69, s65, 1
    s_add_u32 s69, s69, s67
    s_lshl_b32 s77, s65, 8
    v_and_b32 v2, 15, v1
    v_lshrrev_b32 v3, 4, v1
    v_lshlrev_b32 v4, 4, v1
    v_lshlrev_b32 v7, 2, v1
    v_lshrrev_b32 v8, 3, v1
    v_and_b32 v9, 7, v1
    v_and_b32 v10, 6, v8
    v_xor_b32 v10, v9, v10
    v_lshlrev_b32 v10, 4, v10
    v_lshl_add_u32 v16, v8, 10, v10
    v_mov_b32 v28, 0x3f803f80
    v_mov_b32 v29, 0x3f803f80
    v_mov_b32 v30, 0x3f803f80
    v_mov_b32 v31, 0x3f803f80
    v_lshlrev_b32 v17, 8, v2
    v_lshl_add_u32 v17, v3, 4, v17
    s_getreg_b32 s3, hwreg(HW_REG_XCC_ID)
    s_and_b32 s3, s3, 15
    s_memrealtime s[86:87]
    v_lshrrev_b32 v8, 1, v1
    v_and_b32 v9, 1, v1
    v_lshlrev_b32 v9, 4, v9
    v_lshl_add_u32 v5, v8, 7, v9
    v_add_u32 v5, 32768, v5
    s_mov_b32 s75, 0
    s_and_b32 s71, s64, 1
    s_lshl_b32 s71, s71, 5
    v_add_u32 v8, 0, v1
    v_mul_u32_u24 v9, 43691, v8
    v_lshrrev_b32 v9, 19, v9
    v_mul_u32_u24 v10, 12, v9
    v_sub_u32 v8, v8, v10
    v_bfe_u32 v10, v9, 2, 1
    v_xor_b32 v8, v8, v10
    v_mul_u32_u24 v9, 2752, v9
    v_lshl_add_u32 v8, v8, 4, v9
    v_xor_b32 v8, s71, v8
    v_subrev_u32 v172, 0, v8
    v_add_u32 v8, 64, v1
    v_mul_u32_u24 v9, 43691, v8
    v_lshrrev_b32 v9, 19, v9
    v_mul_u32_u24 v10, 12, v9
    v_sub_u32 v8, v8, v10
    v_bfe_u32 v10, v9, 2, 1
    v_xor_b32 v8, v8, v10
    v_mul_u32_u24 v9, 2752, v9
    v_lshl_add_u32 v8, v8, 4, v9
    v_xor_b32 v8, s71, v8
    v_subrev_u32 v173, 1024, v8
    v_add_u32 v8, 128, v1
    v_mul_u32_u24 v9, 43691, v8
    v_lshrrev_b32 v9, 19, v9
    v_mul_u32_u24 v10, 12, v9
    v_sub_u32 v8, v8, v10
    v_bfe_u32 v10, v9, 2, 1
    v_xor_b32 v8, v8, v10
    v_mul_u32_u24 v9, 2752, v9
    v_lshl_add_u32 v8, v8, 4, v9
    v_xor_b32 v8, s71, v8
    v_subrev_u32 v174, 2048, v8
    v_lshlrev_b32 v192, 5, v1
    v_lshrrev_b32 v8, 3, v1
    v_and_b32 v9, 7, v1
    v_and_b32 v10, 2, v8
    v_xor_b32 v10, v9, v10
    v_lshlrev_b32 v10, 4, v10
    v_mul_u32_u24 v32, 3072, v8
    v_add_u32 v32, v32, v10
    v_xor_b32 v33, 64, v32
    v_add_u32 v33, 24576, v33
    s_lshr_b32 s71, s64, 1
    s_lshl_b32 s72, s65, 1
    s_add_u32 s71, s71, s72
    s_mul_i32 s71, s71, 44032
    s_mul_i32 s72, s66, 192
    s_add_u32 s81, s71, s72
    s_cmp_eq_u32 s66, 15
    s_cselect_b32 s81, 0x7f000000, s81
    s_cmp_lt_u32 s2, 64
    s_cselect_b32 s71, 0, 128
    s_cselect_b32 s78, 16, 48
    s_mov_b32 s83, 22020096
    s_cselect_b32 s83, 20971520, s83
    s_lshl_b32 s74, s2, 1
    s_sub_u32 s74, s74, s71
    s_lshr_b32 s71, s74, 3
    s_and_b32 s72, s74, 7
    s_mul_i32 s73, s72, s78
    s_add_u32 s73, s73, s71
    s_lshl_b32 s73, s73, 12
    s_add_u32 s83, s83, s73
    s_lshl_b32 s73, s64, 10
    s_add_u32 s83, s83, s73
    s_lshl_b32 s78, s78, 12
    s_lshl_b32 s71, s71, 15
    s_lshl_b32 s72, s72, 7
    s_add_u32 s71, s71, s72
    s_lshl_b32 s72, s64, 13
    s_add_u32 s82, s71, s72
    s_waitcnt lgkmcnt(0)
    s_and_b32 s71, s64, 1
    s_cmp_eq_u32 s71, 0
    s_cselect_b32 s40, s52, s54
    s_cselect_b32 s41, s53, s55
    s_and_b32 s41, s41, 0xffff
    s_mov_b32 s42, 1409024
    s_mov_b32 s43, 0x20000
    s_mul_i32 s72, s64, 3072
    s_add_u32 m0, s72, 104448
    s_mov_b32 s36, s60
    s_and_b32 s37, s61, 0xffff
    s_mov_b32 s38, 256
    s_mov_b32 s39, 0x20000
    s_lshl_b32 s86, s86, 5
    s_or_b32 s86, s86, 16
    v_mov_b32 v8, s86
    v_mov_b32 v9, 0
    v_mov_b32 v10, 0
    s_lshl_b32 s87, s2, 2
    s_add_u32 s87, s87, s64
    s_and_b32 s87, s87, 0xffffffe3
    s_cmp_eq_u32 s87, 0
    s_cselect_b64 exec, 1, 0
    buffer_atomic_cmpswap v[8:9], v10, s[36:39], 0 offen sc1
    s_mov_b64 exec, -1
    buffer_load_dwordx4 v172, s[40:43], s81 offen offset:0 lds
    buffer_load_dwordx4 v173, s[40:43], s81 offen offset:1024 lds
    buffer_load_dwordx4 v174, s[40:43], s81 offen offset:2048 lds
    s_cmp_lt_u32 s2, 64
    s_cselect_b32 s12, s48, s56
    s_cselect_b32 s13, s49, s57
    s_and_b32 s13, s13, 0xffff
    s_mov_b32 s14, 1409024
    s_cmp_lt_u32 s2, 64
    s_cselect_b32 s14, 524288, s14
    s_mov_b32 s15, 0x20000
    s_add_u32 m0, s73, 116736
    s_nop 0
    buffer_load_dwordx4 v16, s[12:15], s82 offen lds
    s_add_u32 m0, s73, 120832
    s_add_u32 s82, s82, 128
    buffer_load_dwordx4 v16, s[12:15], s82 offen lds
    s_mov_b32 s4, s44
    s_and_b32 s5, s45, 0xffff
    s_mov_b32 s6, 2097152
    s_mov_b32 s7, 0x20000
    s_lshl_b32 s71, s69, 16
    s_lshl_b32 s72, s68, 13
    s_add_u32 s71, s71, s72
    s_lshl_b32 s72, s64, 11
    s_add_u32 s71, s71, s72
    buffer_load_dwordx4 v[180:183], v192, s[4:7], s71 offen
    buffer_load_dwordx4 v[184:187], v192, s[4:7], s71 offen offset:16
    s_mov_b32 s32, s62
    s_and_b32 s33, s63, 0xffff
    s_mov_b32 s34, 33554432
    s_mov_b32 s35, 0x20000
    s_mov_b32 s8, s46
    s_and_b32 s9, s47, 0xffff
    s_mov_b32 s10, 1572864
    s_mov_b32 s11, 0x20000
    s_mov_b32 s28, s58
    s_and_b32 s29, s59, 0xffff
    s_mov_b32 s30, 2097152
    s_mov_b32 s31, 0x20000
    buffer_load_dword v6, v7, s[32:35], s77 offen sc1
    s_lshr_b32 s71, s70, 3
    s_add_u32 s71, s71, s68
    s_and_b32 s71, s71, 1
    s_lshl_b32 s71, s71, 2
    s_and_b32 s72, s2, 7
    s_add_u32 s44, s71, s72
    s_lshl_b32 s71, s69, 16
    s_sub_u32 s71, s71, 16384
    s_lshl_b32 s72, s64, 14
    s_add_u32 s45, s71, s72
    s_add_u32 s46, s45, 8192
    s_max_i32 s45, s45, 0
    s_max_i32 s46, s46, 0
    s_lshr_b32 s63, s64, 1
    s_and_b32 s62, s64, 1
    s_lshl_b32 s73, s63, 13
    s_add_u32 s47, s71, s73
    s_add_u32 s47, s47, 65536
    s_lshl_b32 s48, s64, 11
    s_lshl_b32 s49, s63, 10
    s_add_u32 s49, s49, 8192
    s_mul_i32 s50, s64, 6144
    s_add_u32 s50, s50, 10240
    s_mul_i32 s51, s64, 49152
    s_lshl_b32 s72, s68, 7
    s_add_u32 s51, s51, s72
    s_cmp_eq_u32 s64, 0
    s_cselect_b32 s92, 0xffffff00, -1
    s_mov_b32 s93, -1
    s_cmp_eq_u32 s62, 0
    s_cselect_b32 s94, -1, 0
    s_cselect_b32 s95, 0, -1
    v_mov_b32 v11, 0
    s_cmp_eq_u32 s64, 0
    s_cselect_b64 exec, -1, 0
    buffer_load_dword v6, v11, s[36:39], 0 offen sc1
    s_mov_b64 exec, -1
    s_add_u32 s71, s44, 0
    s_and_b32 s71, s71, 7
    s_mul_i32 s73, s71, 196608
    s_add_u32 s73, s73, s51
    s_lshl_b32 s71, s71, 7
    s_add_u32 m0, s50, 0
    s_nop 0
    buffer_load_dwordx4 v32, s[8:11], s73 offen lds
    buffer_load_dwordx4 v32, s[8:11], s73 offen offset:1024 lds
    buffer_load_dwordx4 v32, s[8:11], s73 offen offset:2048 lds
    s_add_u32 m0, s50, 3072
    s_nop 0
    buffer_load_dwordx4 v33, s[8:11], s73 offen offset:0 lds
    buffer_load_dwordx4 v33, s[8:11], s73 offen offset:1024 lds
    buffer_load_dwordx4 v33, s[8:11], s73 offen offset:2048 lds
    v_lshrrev_b32 v8, 3, v2
    v_and_b32 v9, 7, v2
    v_lshlrev_b32 v9, 7, v9
    v_lshl_add_u32 v8, v8, 10, v9
    v_and_b32 v9, 6, v2
    v_xor_b32 v9, v3, v9
    v_lshl_add_u32 v34, v9, 4, v8
    v_xor_b32 v35, 64, v34
    v_bfe_u32 v8, v1, 2, 2
    v_bfe_u32 v9, v1, 1, 1
    s_lshl_b32 s52, s64, 1
    v_add_u32 v9, s52, v9
    v_and_b32 v10, 1, v3
    v_lshlrev_b32 v10, 2, v10
    v_xor_b32 v9, v9, v10
    v_and_b32 v10, 2, v8
    v_xor_b32 v9, v9, v10
    v_lshlrev_b32 v9, 4, v9
    v_lshl_add_u32 v9, v8, 7, v9
    v_and_b32 v10, 1, v1
    v_lshl_add_u32 v9, v10, 3, v9
    v_mul_u32_u24 v10, 3072, v3
    v_add_u32 v9, v9, v10
    v_add_u32 v36, 10240, v9
    v_add_u32 v37, 69632, v34
    v_add_u32 v38, 69632, v35
    v_add_u32 v39, 69632, v36
    v_lshrrev_b32 v8, 3, v1
    v_mul_u32_u24 v8, 34816, v8
    v_and_b32 v9, 7, v1
    v_lshl_add_u32 v8, v9, 4, v8
    s_mov_b64 exec, 0xffffff
    ds_write_b128 v8, v[28:31]
    s_mov_b64 exec, -1
    v_bfe_u32 v10, v1, 1, 1
    v_lshlrev_b32 v10, 4, v10
    v_and_b32 v11, 1, v1
    v_lshl_add_u32 v10, v11, 3, v10
    s_lshl_b32 s52, s64, 5
    v_xor_b32 v10, s52, v10
    v_bfe_u32 v8, v1, 2, 3
    v_and_b32 v9, 6, v8
    v_lshlrev_b32 v9, 4, v9
    v_xor_b32 v9, v9, v10
    v_lshl_add_u32 v9, v8, 7, v9
    v_lshrrev_b32 v8, 5, v1
    v_lshl_add_u32 v178, v8, 10, v9
    v_add_u32 v179, 2048, v178
    v_bfe_u32 v8, v1, 2, 2
    v_and_b32 v9, 2, v8
    v_lshlrev_b32 v9, 4, v9
    v_xor_b32 v9, v9, v10
    v_lshl_add_u32 v9, v8, 7, v9
    v_lshl_add_u32 v9, v3, 10, v9
    v_xor_b32 v8, 64, v9
    v_add_u32 v8, 512, v8
    s_cmp_lt_u32 s2, 64
    s_cselect_b64 vcc, -1, 0
    v_cndmask_b32 v178, v178, v9, vcc
    v_cndmask_b32 v179, v179, v8, vcc
    v_add_u32 v178, 116736, v178
    v_add_u32 v179, 116736, v179
    v_lshrrev_b32 v8, 2, v1
    v_mul_u32_u24 v8, 192, v8
    v_bfe_u32 v9, v1, 1, 1
    v_mul_u32_u24 v10, 3072, v9
    v_add_u32 v8, v8, v10
    v_add_u32 v8, 104448, v8
    v_and_b32 v10, 1, v3
    v_lshl_add_u32 v9, v9, 1, v10
    v_and_b32 v10, 1, v1
    s_lshl_b32 s54, s63, 2
    s_add_u32 s54, s54, s62
    v_xor_b32 v11, s54, v9
    v_lshl_add_u32 v11, v11, 4, v8
    v_lshl_add_u32 v175, v10, 3, v11
    s_add_u32 s54, s54, 2
    v_xor_b32 v11, s54, v9
    v_lshl_add_u32 v11, v11, 4, v8
    v_lshl_add_u32 v176, v10, 3, v11
    s_add_u32 s54, s63, 8
    v_lshl_add_u32 v11, v10, 1, s54
    v_xor_b32 v11, v11, v9
    v_lshl_add_u32 v11, v11, 4, v8
    s_lshl_b32 s53, s62, 3
    v_add_u32 v177, s53, v11
    s_lshl_b32 s60, s64, 12
    s_mul_i32 s79, s64, 11
    s_min_u32 s79, s79, 32
    s_lshl_b32 s52, s66, 2
    s_add_u32 s52, s52, s64
    s_mul_i32 s80, s52, 49152
    s_add_u32 s80, s80, 16777216
    s_lshl_b32 s61, s52, 2
    s_add_u32 s61, s61, s77
    s_and_b32 s18, s65, 1
    s_lshl_b32 s18, s18, 10
    s_add_u32 s18, s18, s80
    s_add_u32 s18, s18, s32
    s_addc_u32 s19, s33, 0
    s_lshl_b32 s53, s62, 11
    s_xor_b32 s54, s53, 2048
    s_lshl_b32 s55, s68, 16
    s_lshl_b32 s56, s64, 14
    s_add_u32 s55, s55, s56
    s_add_u32 s55, s55, 20971520
    s_add_u32 s12, s55, s53
    s_add_u32 s13, s55, s54
    s_mul_i32 s55, s68, 48
    s_add_u32 s56, s55, s79
    s_lshl_b32 s56, s56, 12
    s_add_u32 s56, s56, 22020096
    s_add_u32 s14, s56, s53
    s_add_u32 s15, s56, s54
    s_add_u32 s55, s55, 43
    s_lshl_b32 s55, s55, 12
    s_add_u32 s55, s55, 22020096
    s_cmp_eq_u32 s64, 3
    s_cselect_b32 s16, s55, s14
    s_cselect_b32 s17, s55, s15
    v_and_b32 v8, 3, v2
    v_cmp_eq_u32 s[84:85], 1, v8
    v_cmp_eq_u32 s[86:87], 2, v8
    v_cmp_eq_u32 s[88:89], 3, v8
    v_lshrrev_b32 v8, 2, v2
    v_cmp_eq_u32 s[90:91], v8, v3
    s_cmp_eq_u32 s64, 0
    s_cselect_b32 s96, 1, 0
    s_mov_b32 s97, 0
    s_cmp_eq_u32 s67, 0
    s_cselect_b32 s98, -1, 0
    s_cselect_b32 s99, 0, -1
    v_lshlrev_b32 v8, 2, v3
    v_sub_u32 v8, v8, v2
    v_mov_b32 v11, 0xf149f2ca
    s_cmp_eq_u32 s69, 0
    s_cselect_b64 s[58:59], -1, 0
    v_add_u32 v9, 0, v8
    v_and_b32 v10, 1, v9
    v_cmp_eq_u32 s[52:53], 0, v10
    v_cmp_le_i32 s[54:55], 2, v9
    v_cmp_ge_i32 s[56:57], 0, v9
    s_nop 0
    s_and_b64 s[54:55], s[54:55], s[52:53]
    s_and_b64 s[56:57], s[56:57], s[52:53]
    v_cndmask_b32 v196, v11, 0, s[54:55]
    v_cndmask_b32 v200, v11, 0, s[56:57]
    v_cndmask_b32 v204, v196, v11, s[58:59]
    v_add_u32 v9, 1, v8
    v_and_b32 v10, 1, v9
    v_cmp_eq_u32 s[52:53], 0, v10
    v_cmp_le_i32 s[54:55], 2, v9
    v_cmp_ge_i32 s[56:57], 0, v9
    s_nop 0
    s_and_b64 s[54:55], s[54:55], s[52:53]
    s_and_b64 s[56:57], s[56:57], s[52:53]
    v_cndmask_b32 v197, v11, 0, s[54:55]
    v_cndmask_b32 v201, v11, 0, s[56:57]
    v_cndmask_b32 v205, v197, v11, s[58:59]
    v_add_u32 v9, 2, v8
    v_and_b32 v10, 1, v9
    v_cmp_eq_u32 s[52:53], 0, v10
    v_cmp_le_i32 s[54:55], 2, v9
    v_cmp_ge_i32 s[56:57], 0, v9
    s_nop 0
    s_and_b64 s[54:55], s[54:55], s[52:53]
    s_and_b64 s[56:57], s[56:57], s[52:53]
    v_cndmask_b32 v198, v11, 0, s[54:55]
    v_cndmask_b32 v202, v11, 0, s[56:57]
    v_cndmask_b32 v206, v198, v11, s[58:59]
    v_add_u32 v9, 3, v8
    v_and_b32 v10, 1, v9
    v_cmp_eq_u32 s[52:53], 0, v10
    v_cmp_le_i32 s[54:55], 2, v9
    v_cmp_ge_i32 s[56:57], 0, v9
    s_nop 0
    s_and_b64 s[54:55], s[54:55], s[52:53]
    s_and_b64 s[56:57], s[56:57], s[52:53]
    v_cndmask_b32 v199, v11, 0, s[54:55]
    v_cndmask_b32 v203, v11, 0, s[56:57]
    v_cndmask_b32 v207, v199, v11, s[58:59]
    v_and_b32 v9, 1, v2
    v_cmp_eq_u32 vcc, 1, v9
    v_mov_b32 v9, 0x0c0c0100
    v_mov_b32 v10, 0x01000c0c
    v_cndmask_b32 v208, v9, v10, vcc
    v_mov_b32 v9, 0x0c0c0302
    v_mov_b32 v10, 0x03020c0c
    v_cndmask_b32 v209, v9, v10, vcc
    v_lshlrev_b32 v40, 2, v2
    v_add_u32 v40, 153600, v40
    v_lshlrev_b32 v41, 4, v3
    v_add_u32 v41, 153600, v41
    s_lshl_b32 s52, s69, 6
    s_lshl_b32 s53, s62, 6
    s_add_u32 s52, s52, s53
    s_sub_u32 s52, s52, 16
    v_add_u32 v42, s52, v1
    v_max_i32 v42, 0, v42
    v_min_i32 v42, 2047, v42
    v_and_b32 v8, 1, v42
    v_lshrrev_b32 v42, 1, v42
    v_lshlrev_b32 v42, 7, v42
    v_lshl_add_u32 v42, v8, 3, v42
    v_and_b32 v8, 1, v3
    v_lshlrev_b32 v8, 14, v8
    v_lshrrev_b32 v9, 1, v3
    v_lshl_add_u32 v8, v9, 8, v8
    v_lshl_add_u32 v43, v2, 4, v8
    s_mov_b64 exec, s[92:93]
    s_add_u32 m0, s48, 0
    s_add_u32 s72, s45, s71
    buffer_load_dwordx4 v16, s[4:7], s72 offen lds
    s_mov_b64 exec, -1
    s_add_u32 m0, s48, 1024
    s_add_u32 s72, s46, s71
    buffer_load_dwordx4 v16, s[4:7], s72 offen lds
    s_mov_b64 exec, s[94:95]
    s_add_u32 m0, s49, 0
    s_add_u32 s72, s47, s71
    buffer_load_dwordx4 v16, s[4:7], s72 offen lds
    s_mov_b64 exec, -1
    s_add_u32 s71, s44, 1
    s_and_b32 s71, s71, 7
    s_mul_i32 s73, s71, 196608
    s_add_u32 s73, s73, s51
    s_lshl_b32 s71, s71, 7
    s_add_u32 m0, s50, 34816
    s_nop 0
    buffer_load_dwordx4 v32, s[8:11], s73 offen lds
    buffer_load_dwordx4 v32, s[8:11], s73 offen offset:1024 lds
    buffer_load_dwordx4 v32, s[8:11], s73 offen offset:2048 lds
    s_add_u32 m0, s50, 37888
    s_nop 0
    buffer_load_dwordx4 v33, s[8:11], s73 offen offset:0 lds
    buffer_load_dwordx4 v33, s[8:11], s73 offen offset:1024 lds
    buffer_load_dwordx4 v33, s[8:11], s73 offen offset:2048 lds
    s_mov_b64 exec, s[92:93]
    s_add_u32 m0, s48, 34816
    s_add_u32 s72, s45, s71
    buffer_load_dwordx4 v16, s[4:7], s72 offen lds
    s_mov_b64 exec, -1
    s_add_u32 m0, s48, 35840
    s_add_u32 s72, s46, s71
    buffer_load_dwordx4 v16, s[4:7], s72 offen lds
    s_mov_b64 exec, s[94:95]
    s_add_u32 m0, s49, 34816
    s_add_u32 s72, s47, s71
    buffer_load_dwordx4 v16, s[4:7], s72 offen lds
    s_mov_b64 exec, -1
    s_waitcnt vmcnt(18)
    s_nop 1
    s_cmp_eq_u32 s64, 0
    s_cbranch_scc0 L_skip1
    s_mov_b32 s74, 0
    v_mov_b32 v11, 0
L_wait1:
    v_readfirstlane_b32 s76, v6
    s_nop 1
    s_cmp_lg_u32 s76, 0
    s_cbranch_scc1 L_go1
    s_sleep 2
    buffer_load_dword v6, v11, s[36:39], 0 offen sc1
    s_waitcnt vmcnt(0)
    s_add_u32 s74, s74, 1
    s_cmp_lt_u32 s74, 0x20000
    s_cbranch_scc1 L_wait1
L_go1:
    s_nop 1
    v_mov_b32 v9, 155652
    ds_write_b32 v9, v6
L_skip1:
    s_nop 3
    s_waitcnt lgkmcnt(0)
    s_barrier
    v_mov_b32 v9, 155652
    ds_read_b32 v10, v9
    ds_read_b64_tr_b16 v[212:213], v175 offset:0
    ds_read_b64_tr_b16 v[214:215], v175 offset:6144
    ds_read_b64_tr_b16 v[216:217], v176 offset:0
    ds_read_b64_tr_b16 v[218:219], v176 offset:6144
    ds_read_b64_tr_b16 v[220:221], v177 offset:0
    ds_read_b64_tr_b16 v[222:223], v177 offset:6144
    ds_read_b64_tr_b16 v[224:225], v178 offset:0
    ds_read_b64_tr_b16 v[226:227], v179 offset:0
    ds_read_b64_tr_b16 v[228:229], v178 offset:4096
    ds_read_b64_tr_b16 v[230:231], v179 offset:4096
    s_lshl_b32 s71, s66, 2
    s_add_u32 s71, s71, s64
    s_mul_i32 s72, s65, 3072
    s_add_u32 s72, s72, s80
    v_mov_b32 v188, 0
    v_mov_b32 v189, 0
    s_waitcnt lgkmcnt(10)
    v_readfirstlane_b32 s76, v10
    s_waitcnt lgkmcnt(8)
    buffer_store_dwordx4 v[212:215], v4, s[32:35], s72 offen offset:0 sc1
    v_mfma_f32_16x16x32_bf16 v[232:235], v[212:215], v[28:31], 0
    s_waitcnt lgkmcnt(6)
    buffer_store_dwordx4 v[216:219], v4, s[32:35], s72 offen offset:1024 sc1
    v_mfma_f32_16x16x32_bf16 v[236:239], v[216:219], v[28:31], 0
    s_waitcnt lgkmcnt(4)
    buffer_store_dwordx4 v[220:223], v4, s[32:35], s72 offen offset:2048 sc1
    v_mfma_f32_16x16x32_bf16 v[240:243], v[220:223], v[28:31], 0
    s_waitcnt lgkmcnt(2)
    buffer_store_dwordx4 v[224:227], v4, s[32:35], s83 offen sc1
    s_add_u32 s83, s83, s78
    s_waitcnt lgkmcnt(0)
    buffer_store_dwordx4 v[228:231], v4, s[32:35], s83 offen sc1
    s_lshl_b32 s71, s71, 12
    s_lshl_b32 s72, s65, 8
    s_add_u32 s71, s71, s72
    s_add_u32 s71, s71, 24117248
    s_mov_b32 exec_lo, 0x00010001
    s_mov_b32 exec_hi, 0x00010001
    buffer_store_dwordx4 v[232:235], v17, s[32:35], s71 offen offset:0 sc1
    buffer_store_dwordx4 v[236:239], v17, s[32:35], s71 offen offset:64 sc1
    buffer_store_dwordx4 v[240:243], v17, s[32:35], s71 offen offset:128 sc1
    s_mov_b64 exec, -1
    v_dot2_f32_bf16 v188, v180, v28, v188
    v_dot2_f32_bf16 v189, v180, v180, v189
    v_dot2_f32_bf16 v188, v181, v28, v188
    v_dot2_f32_bf16 v189, v181, v181, v189
    v_dot2_f32_bf16 v188, v182, v28, v188
    v_dot2_f32_bf16 v189, v182, v182, v189
    v_dot2_f32_bf16 v188, v183, v28, v188
    v_dot2_f32_bf16 v189, v183, v183, v189
    v_dot2_f32_bf16 v188, v184, v28, v188
    v_dot2_f32_bf16 v189, v184, v184, v189
    v_dot2_f32_bf16 v188, v185, v28, v188
    v_dot2_f32_bf16 v189, v185, v185, v189
    v_dot2_f32_bf16 v188, v186, v28, v188
    v_dot2_f32_bf16 v189, v186, v186, v189
    v_dot2_f32_bf16 v188, v187, v28, v188
    v_dot2_f32_bf16 v189, v187, v187, v189
    s_nop 1
    v_add_f32_dpp v188, v188, v188 quad_perm:[1,0,3,2] row_mask:0xf bank_mask:0xf
    v_add_f32_dpp v189, v189, v189 quad_perm:[1,0,3,2] row_mask:0xf bank_mask:0xf
    s_nop 0
    v_add_f32_dpp v188, v188, v188 quad_perm:[2,3,0,1] row_mask:0xf bank_mask:0xf
    v_add_f32_dpp v189, v189, v189 quad_perm:[2,3,0,1] row_mask:0xf bank_mask:0xf
    s_nop 0
    v_add_f32_dpp v188, v188, v188 row_half_mirror row_mask:0xf bank_mask:0xf
    v_add_f32_dpp v189, v189, v189 row_half_mirror row_mask:0xf bank_mask:0xf
    s_nop 0
    v_add_f32_dpp v188, v188, v188 row_mirror row_mask:0xf bank_mask:0xf
    v_add_f32_dpp v189, v189, v189 row_mirror row_mask:0xf bank_mask:0xf
    v_mov_b32 v190, v188
    v_mov_b32 v191, v189
    v_lshrrev_b32 v8, 5, v1
    v_lshlrev_b32 v8, 3, v8
    v_permlane16_swap_b32 v188, v190
    v_permlane16_swap_b32 v189, v191
    v_add_f32 v188, v188, v190
    v_add_f32 v189, v189, v191
    v_mul_f32 v188, 0x3b000000, v188
    v_mul_f32 v189, 0x3b000000, v189
    v_fma_f32 v189, -v188, v188, v189
    v_max_f32 v189, 0, v189
    v_add_f32 v189, 0x3727c5ac, v189
    v_rsq_f32 v189, v189
    s_lshl_b32 s71, s69, 12
    s_lshl_b32 s72, s68, 9
    s_add_u32 s71, s71, s72
    s_lshl_b32 s72, s64, 7
    s_add_u32 s71, s71, s72
    s_add_u32 s71, s71, 24641536
    s_mov_b32 exec_lo, 1
    s_mov_b32 exec_hi, 1
    buffer_store_dwordx2 v[188:189], v8, s[32:35], s71 offen sc1
    s_mov_b64 exec, -1
    s_waitcnt vmcnt(18)
    s_waitcnt lgkmcnt(0)
    s_barrier
    ds_read_b64_tr_b16 v[148:149], v36 offset:0
    ds_read_b64_tr_b16 v[150:151], v36 offset:512
    ds_read_b64_tr_b16 v[152:153], v36 offset:1024
    ds_read_b64_tr_b16 v[154:155], v36 offset:1536
    ds_read_b64_tr_b16 v[156:157], v36 offset:2048
    ds_read_b64_tr_b16 v[158:159], v36 offset:2560
    ds_read_b128 v[108:111], v34 offset:0
    ds_read_b128 v[112:115], v34 offset:2048
    ds_read_b128 v[116:119], v34 offset:4096
    ds_read_b128 v[120:123], v34 offset:6144
    ds_read_b128 v[124:127], v34 offset:8192
    s_add_u32 s71, s44, 2
    s_and_b32 s71, s71, 7
    s_mul_i32 s73, s71, 196608
    s_add_u32 s73, s73, s51
    s_lshl_b32 s71, s71, 7
    s_add_u32 m0, s50, 69632
    s_nop 0
    buffer_load_dwordx4 v32, s[8:11], s73 offen lds
    buffer_load_dwordx4 v32, s[8:11], s73 offen offset:1024 lds
    buffer_load_dwordx4 v32, s[8:11], s73 offen offset:2048 lds
    s_add_u32 m0, s50, 72704
    s_nop 0
    buffer_load_dwordx4 v33, s[8:11], s73 offen offset:0 lds
    buffer_load_dwordx4 v33, s[8:11], s73 offen offset:1024 lds
    buffer_load_dwordx4 v33, s[8:11], s73 offen offset:2048 lds
    s_mov_b64 exec, s[92:93]
    s_add_u32 m0, s48, 69632
    s_add_u32 s72, s45, s71
    buffer_load_dwordx4 v16, s[4:7], s72 offen lds
    s_mov_b64 exec, -1
    s_add_u32 m0, s48, 70656
    s_add_u32 s72, s46, s71
    buffer_load_dwordx4 v16, s[4:7], s72 offen lds
    s_mov_b64 exec, s[94:95]
    s_add_u32 m0, s49, 69632
    s_add_u32 s72, s47, s71
    buffer_load_dwordx4 v16, s[4:7], s72 offen lds
    s_mov_b64 exec, -1
    s_waitcnt lgkmcnt(0)
    v_mfma_f32_16x16x32_bf16 v[48:51], v[148:151], v[108:111], 0
    ds_read_b64_tr_b16 v[160:161], v36 offset:12288
    ds_read_b64_tr_b16 v[162:163], v36 offset:12800
    v_mfma_f32_16x16x32_bf16 v[68:71], v[152:155], v[108:111], 0
    ds_read_b64_tr_b16 v[164:165], v36 offset:13312
    ds_read_b64_tr_b16 v[166:167], v36 offset:13824
    v_mfma_f32_16x16x32_bf16 v[88:91], v[108:111], v[156:159], 0
    ds_read_b64_tr_b16 v[168:169], v36 offset:14336
    ds_read_b64_tr_b16 v[170:171], v36 offset:14848
    v_mfma_f32_16x16x32_bf16 v[52:55], v[148:151], v[112:115], 0
    ds_read_b128 v[128:131], v35 offset:0
    ds_read_b128 v[132:135], v35 offset:2048
    v_mfma_f32_16x16x32_bf16 v[72:75], v[152:155], v[112:115], 0
    ds_read_b128 v[136:139], v35 offset:4096
    ds_read_b128 v[140:143], v35 offset:6144
    v_mfma_f32_16x16x32_bf16 v[92:95], v[112:115], v[156:159], 0
    ds_read_b128 v[144:147], v35 offset:8192
    v_mfma_f32_16x16x32_bf16 v[56:59], v[148:151], v[116:119], 0
    v_mfma_f32_16x16x32_bf16 v[76:79], v[152:155], v[116:119], 0
    v_mfma_f32_16x16x32_bf16 v[96:99], v[116:119], v[156:159], 0
    v_mfma_f32_16x16x32_bf16 v[60:63], v[148:151], v[120:123], 0
    v_mfma_f32_16x16x32_bf16 v[80:83], v[152:155], v[120:123], 0
    v_mfma_f32_16x16x32_bf16 v[100:103], v[120:123], v[156:159], 0
    v_mfma_f32_16x16x32_bf16 v[64:67], v[148:151], v[124:127], 0
    v_mfma_f32_16x16x32_bf16 v[84:87], v[152:155], v[124:127], 0
    v_mfma_f32_16x16x32_bf16 v[104:107], v[124:127], v[156:159], 0
    s_waitcnt vmcnt(18)
    s_waitcnt vmcnt(9)
    s_waitcnt lgkmcnt(0)
    s_barrier
    s_add_u32 s71, s76, s3
    v_mov_b32 v8, s71
    v_mov_b32 v9, 0
    s_lshl_b32 s71, s69, 7
    s_lshl_b32 s72, s68, 2
    s_add_u32 s71, s71, s72
    s_add_u32 s71, s71, 32768
    s_mov_b64 exec, s[96:97]
    buffer_store_dword v8, v9, s[32:35], s71 offen sc1
    s_mov_b64 exec, -1
    v_mfma_f32_16x16x32_bf16 v[48:51], v[160:163], v[128:131], v[48:51]
    ds_read_b64_tr_b16 v[148:149], v36 offset:34816
    ds_read_b64_tr_b16 v[150:151], v36 offset:35328
    v_mfma_f32_16x16x32_bf16 v[68:71], v[164:167], v[128:131], v[68:71]
    ds_read_b64_tr_b16 v[152:153], v36 offset:35840
    ds_read_b64_tr_b16 v[154:155], v36 offset:36352
    v_mfma_f32_16x16x32_bf16 v[88:91], v[128:131], v[168:171], v[88:91]
    ds_read_b64_tr_b16 v[156:157], v36 offset:36864
    ds_read_b64_tr_b16 v[158:159], v36 offset:37376
    v_mfma_f32_16x16x32_bf16 v[52:55], v[160:163], v[132:135], v[52:55]
    ds_read_b128 v[108:111], v34 offset:34816
    ds_read_b128 v[112:115], v34 offset:36864
    v_mfma_f32_16x16x32_bf16 v[72:75], v[164:167], v[132:135], v[72:75]
    ds_read_b128 v[116:119], v34 offset:38912
    ds_read_b128 v[120:123], v34 offset:40960
    v_mfma_f32_16x16x32_bf16 v[92:95], v[132:135], v[168:171], v[92:95]
    ds_read_b128 v[124:127], v34 offset:43008
    v_mfma_f32_16x16x32_bf16 v[56:59], v[160:163], v[136:139], v[56:59]
    v_mfma_f32_16x16x32_bf16 v[76:79], v[164:167], v[136:139], v[76:79]
    s_add_u32 s71, s44, 3
    s_and_b32 s71, s71, 7
    s_mul_i32 s73, s71, 196608
    s_add_u32 s73, s73, s51
    s_lshl_b32 s71, s71, 7
    s_add_u32 m0, s50, 0
    s_nop 0
    buffer_load_dwordx4 v32, s[8:11], s73 offen lds
    v_mfma_f32_16x16x32_bf16 v[96:99], v[136:139], v[168:171], v[96:99]
    v_mfma_f32_16x16x32_bf16 v[60:63], v[160:163], v[140:143], v[60:63]
    buffer_load_dwordx4 v32, s[8:11], s73 offen offset:1024 lds
    v_mfma_f32_16x16x32_bf16 v[80:83], v[164:167], v[140:143], v[80:83]
    v_mfma_f32_16x16x32_bf16 v[100:103], v[140:143], v[168:171], v[100:103]
    buffer_load_dwordx4 v32, s[8:11], s73 offen offset:2048 lds
    v_mfma_f32_16x16x32_bf16 v[64:67], v[160:163], v[144:147], v[64:67]
    v_mfma_f32_16x16x32_bf16 v[84:87], v[164:167], v[144:147], v[84:87]
    s_add_u32 m0, s50, 3072
    s_nop 0
    buffer_load_dwordx4 v33, s[8:11], s73 offen offset:0 lds
    v_mfma_f32_16x16x32_bf16 v[104:107], v[144:147], v[168:171], v[104:107]
    buffer_load_dwordx4 v33, s[8:11], s73 offen offset:1024 lds
    s_waitcnt lgkmcnt(0)
    v_mfma_f32_16x16x32_bf16 v[48:51], v[148:151], v[108:111], v[48:51]
    ds_read_b64_tr_b16 v[160:161], v36 offset:47104
    ds_read_b64_tr_b16 v[162:163], v36 offset:47616
    v_mfma_f32_16x16x32_bf16 v[68:71], v[152:155], v[108:111], v[68:71]
    ds_read_b64_tr_b16 v[164:165], v36 offset:48128
    ds_read_b64_tr_b16 v[166:167], v36 offset:48640
    v_mfma_f32_16x16x32_bf16 v[88:91], v[108:111], v[156:159], v[88:91]
    ds_read_b64_tr_b16 v[168:169], v36 offset:49152
    ds_read_b64_tr_b16 v[170:171], v36 offset:49664
    v_mfma_f32_16x16x32_bf16 v[52:55], v[148:151], v[112:115], v[52:55]
    ds_read_b128 v[128:131], v35 offset:34816
    ds_read_b128 v[132:135], v35 offset:36864
    v_mfma_f32_16x16x32_bf16 v[72:75], v[152:155], v[112:115], v[72:75]
    ds_read_b128 v[136:139], v35 offset:38912
    ds_read_b128 v[140:143], v35 offset:40960
    v_mfma_f32_16x16x32_bf16 v[92:95], v[112:115], v[156:159], v[92:95]
    ds_read_b128 v[144:147], v35 offset:43008
    buffer_load_dwordx4 v33, s[8:11], s73 offen offset:2048 lds
    v_mfma_f32_16x16x32_bf16 v[56:59], v[148:151], v[116:119], v[56:59]
    s_mov_b64 exec, s[92:93]
    s_add_u32 m0, s48, 0
    s_add_u32 s72, s45, s71
    buffer_load_dwordx4 v16, s[4:7], s72 offen lds
    s_mov_b64 exec, -1
    v_mfma_f32_16x16x32_bf16 v[76:79], v[152:155], v[116:119], v[76:79]
    s_add_u32 m0, s48, 1024
    s_add_u32 s72, s46, s71
    buffer_load_dwordx4 v16, s[4:7], s72 offen lds
    v_mfma_f32_16x16x32_bf16 v[96:99], v[116:119], v[156:159], v[96:99]
    s_mov_b64 exec, s[94:95]
    s_add_u32 m0, s49, 0
    s_add_u32 s72, s47, s71
    buffer_load_dwordx4 v16, s[4:7], s72 offen lds
    s_mov_b64 exec, -1
    v_mfma_f32_16x16x32_bf16 v[60:63], v[148:151], v[120:123], v[60:63]
    v_mfma_f32_16x16x32_bf16 v[80:83], v[152:155], v[120:123], v[80:83]
    v_mfma_f32_16x16x32_bf16 v[100:103], v[120:123], v[156:159], v[100:103]
    v_mfma_f32_16x16x32_bf16 v[64:67], v[148:151], v[124:127], v[64:67]
    v_mfma_f32_16x16x32_bf16 v[84:87], v[152:155], v[124:127], v[84:87]
    v_mfma_f32_16x16x32_bf16 v[104:107], v[124:127], v[156:159], v[104:107]
    s_waitcnt vmcnt(9)
    s_waitcnt lgkmcnt(0)
    s_barrier
    v_mfma_f32_16x16x32_bf16 v[48:51], v[160:163], v[128:131], v[48:51]
    ds_read_b64_tr_b16 v[148:149], v39 offset:0
    ds_read_b64_tr_b16 v[150:151], v39 offset:512
    v_mfma_f32_16x16x32_bf16 v[68:71], v[164:167], v[128:131], v[68:71]
    ds_read_b64_tr_b16 v[152:153], v39 offset:1024
    ds_read_b64_tr_b16 v[154:155], v39 offset:1536
    v_mfma_f32_16x16x32_bf16 v[88:91], v[128:131], v[168:171], v[88:91]
    ds_read_b64_tr_b16 v[156:157], v39 offset:2048
    ds_read_b64_tr_b16 v[158:159], v39 offset:2560
    v_mfma_f32_16x16x32_bf16 v[52:55], v[160:163], v[132:135], v[52:55]
    ds_read_b128 v[108:111], v37 offset:0
    ds_read_b128 v[112:115], v37 offset:2048
    v_mfma_f32_16x16x32_bf16 v[72:75], v[164:167], v[132:135], v[72:75]
    ds_read_b128 v[116:119], v37 offset:4096
    ds_read_b128 v[120:123], v37 offset:6144
    v_mfma_f32_16x16x32_bf16 v[92:95], v[132:135], v[168:171], v[92:95]
    ds_read_b128 v[124:127], v37 offset:8192
    v_mfma_f32_16x16x32_bf16 v[56:59], v[160:163], v[136:139], v[56:59]
    v_mfma_f32_16x16x32_bf16 v[76:79], v[164:167], v[136:139], v[76:79]
    s_add_u32 s71, s44, 4
    s_and_b32 s71, s71, 7
    s_mul_i32 s73, s71, 196608
    s_add_u32 s73, s73, s51
    s_lshl_b32 s71, s71, 7
    s_add_u32 m0, s50, 34816
    s_nop 0
    buffer_load_dwordx4 v32, s[8:11], s73 offen lds
    v_mfma_f32_16x16x32_bf16 v[96:99], v[136:139], v[168:171], v[96:99]
    v_mfma_f32_16x16x32_bf16 v[60:63], v[160:163], v[140:143], v[60:63]
    buffer_load_dwordx4 v32, s[8:11], s73 offen offset:1024 lds
    v_mfma_f32_16x16x32_bf16 v[80:83], v[164:167], v[140:143], v[80:83]
    v_mfma_f32_16x16x32_bf16 v[100:103], v[140:143], v[168:171], v[100:103]
    buffer_load_dwordx4 v32, s[8:11], s73 offen offset:2048 lds
    v_mfma_f32_16x16x32_bf16 v[64:67], v[160:163], v[144:147], v[64:67]
    v_mfma_f32_16x16x32_bf16 v[84:87], v[164:167], v[144:147], v[84:87]
    s_add_u32 m0, s50, 37888
    s_nop 0
    buffer_load_dwordx4 v33, s[8:11], s73 offen offset:0 lds
    v_mfma_f32_16x16x32_bf16 v[104:107], v[144:147], v[168:171], v[104:107]
    buffer_load_dwordx4 v33, s[8:11], s73 offen offset:1024 lds
    s_waitcnt lgkmcnt(0)
    v_mfma_f32_16x16x32_bf16 v[48:51], v[148:151], v[108:111], v[48:51]
    ds_read_b64_tr_b16 v[160:161], v39 offset:12288
    ds_read_b64_tr_b16 v[162:163], v39 offset:12800
    v_mfma_f32_16x16x32_bf16 v[68:71], v[152:155], v[108:111], v[68:71]
    ds_read_b64_tr_b16 v[164:165], v39 offset:13312
    ds_read_b64_tr_b16 v[166:167], v39 offset:13824
    v_mfma_f32_16x16x32_bf16 v[88:91], v[108:111], v[156:159], v[88:91]
    ds_read_b64_tr_b16 v[168:169], v39 offset:14336
    ds_read_b64_tr_b16 v[170:171], v39 offset:14848
    v_mfma_f32_16x16x32_bf16 v[52:55], v[148:151], v[112:115], v[52:55]
    ds_read_b128 v[128:131], v38 offset:0
    ds_read_b128 v[132:135], v38 offset:2048
    v_mfma_f32_16x16x32_bf16 v[72:75], v[152:155], v[112:115], v[72:75]
    ds_read_b128 v[136:139], v38 offset:4096
    ds_read_b128 v[140:143], v38 offset:6144
    v_mfma_f32_16x16x32_bf16 v[92:95], v[112:115], v[156:159], v[92:95]
    ds_read_b128 v[144:147], v38 offset:8192
    buffer_load_dwordx4 v33, s[8:11], s73 offen offset:2048 lds
    v_mfma_f32_16x16x32_bf16 v[56:59], v[148:151], v[116:119], v[56:59]
    s_mov_b64 exec, s[92:93]
    s_add_u32 m0, s48, 34816
    s_add_u32 s72, s45, s71
    buffer_load_dwordx4 v16, s[4:7], s72 offen lds
    s_mov_b64 exec, -1
    v_mfma_f32_16x16x32_bf16 v[76:79], v[152:155], v[116:119], v[76:79]
    s_add_u32 m0, s48, 35840
    s_add_u32 s72, s46, s71
    buffer_load_dwordx4 v16, s[4:7], s72 offen lds
    v_mfma_f32_16x16x32_bf16 v[96:99], v[116:119], v[156:159], v[96:99]
    s_mov_b64 exec, s[94:95]
    s_add_u32 m0, s49, 34816
    s_add_u32 s72, s47, s71
    buffer_load_dwordx4 v16, s[4:7], s72 offen lds
    s_mov_b64 exec, -1
    v_mfma_f32_16x16x32_bf16 v[60:63], v[148:151], v[120:123], v[60:63]
    v_mfma_f32_16x16x32_bf16 v[80:83], v[152:155], v[120:123], v[80:83]
    v_mfma_f32_16x16x32_bf16 v[100:103], v[120:123], v[156:159], v[100:103]
    v_mfma_f32_16x16x32_bf16 v[64:67], v[148:151], v[124:127], v[64:67]
    v_mfma_f32_16x16x32_bf16 v[84:87], v[152:155], v[124:127], v[84:87]
    v_mfma_f32_16x16x32_bf16 v[104:107], v[124:127], v[156:159], v[104:107]
    s_waitcnt vmcnt(9)
    s_waitcnt lgkmcnt(0)
    s_barrier
    v_mfma_f32_16x16x32_bf16 v[48:51], v[160:163], v[128:131], v[48:51]
    ds_read_b64_tr_b16 v[148:149], v36 offset:0
    ds_read_b64_tr_b16 v[150:151], v36 offset:512
    v_mfma_f32_16x16x32_bf16 v[68:71], v[164:167], v[128:131], v[68:71]
    ds_read_b64_tr_b16 v[152:153], v36 offset:1024
    ds_read_b64_tr_b16 v[154:155], v36 offset:1536
    v_mfma_f32_16x16x32_bf16 v[88:91], v[128:131], v[168:171], v[88:91]
    ds_read_b64_tr_b16 v[156:157], v36 offset:2048
    ds_read_b64_tr_b16 v[158:159], v36 offset:2560
    v_mfma_f32_16x16x32_bf16 v[52:55], v[160:163], v[132:135], v[52:55]
    ds_read_b128 v[108:111], v34 offset:0
    ds_read_b128 v[112:115], v34 offset:2048
    v_mfma_f32_16x16x32_bf16 v[72:75], v[164:167], v[132:135], v[72:75]
    ds_read_b128 v[116:119], v34 offset:4096
    ds_read_b128 v[120:123], v34 offset:6144
    v_mfma_f32_16x16x32_bf16 v[92:95], v[132:135], v[168:171], v[92:95]
    ds_read_b128 v[124:127], v34 offset:8192
    v_mfma_f32_16x16x32_bf16 v[56:59], v[160:163], v[136:139], v[56:59]
    v_mfma_f32_16x16x32_bf16 v[76:79], v[164:167], v[136:139], v[76:79]
    s_add_u32 s71, s44, 5
    s_and_b32 s71, s71, 7
    s_mul_i32 s73, s71, 196608
    s_add_u32 s73, s73, s51
    s_lshl_b32 s71, s71, 7
    s_add_u32 m0, s50, 69632
    s_nop 0
    buffer_load_dwordx4 v32, s[8:11], s73 offen lds
    v_mfma_f32_16x16x32_bf16 v[96:99], v[136:139], v[168:171], v[96:99]
    v_mfma_f32_16x16x32_bf16 v[60:63], v[160:163], v[140:143], v[60:63]
    buffer_load_dwordx4 v32, s[8:11], s73 offen offset:1024 lds
    v_mfma_f32_16x16x32_bf16 v[80:83], v[164:167], v[140:143], v[80:83]
    v_mfma_f32_16x16x32_bf16 v[100:103], v[140:143], v[168:171], v[100:103]
    buffer_load_dwordx4 v32, s[8:11], s73 offen offset:2048 lds
    v_mfma_f32_16x16x32_bf16 v[64:67], v[160:163], v[144:147], v[64:67]
    v_mfma_f32_16x16x32_bf16 v[84:87], v[164:167], v[144:147], v[84:87]
    s_add_u32 m0, s50, 72704
    s_nop 0
    buffer_load_dwordx4 v33, s[8:11], s73 offen offset:0 lds
    v_mfma_f32_16x16x32_bf16 v[104:107], v[144:147], v[168:171], v[104:107]
    buffer_load_dwordx4 v33, s[8:11], s73 offen offset:1024 lds
    s_waitcnt lgkmcnt(0)
    v_mfma_f32_16x16x32_bf16 v[48:51], v[148:151], v[108:111], v[48:51]
    ds_read_b64_tr_b16 v[160:161], v36 offset:12288
    ds_read_b64_tr_b16 v[162:163], v36 offset:12800
    v_mfma_f32_16x16x32_bf16 v[68:71], v[152:155], v[108:111], v[68:71]
    ds_read_b64_tr_b16 v[164:165], v36 offset:13312
    ds_read_b64_tr_b16 v[166:167], v36 offset:13824
    v_mfma_f32_16x16x32_bf16 v[88:91], v[108:111], v[156:159], v[88:91]
    ds_read_b64_tr_b16 v[168:169], v36 offset:14336
    ds_read_b64_tr_b16 v[170:171], v36 offset:14848
    v_mfma_f32_16x16x32_bf16 v[52:55], v[148:151], v[112:115], v[52:55]
    ds_read_b128 v[128:131], v35 offset:0
    ds_read_b128 v[132:135], v35 offset:2048
    v_mfma_f32_16x16x32_bf16 v[72:75], v[152:155], v[112:115], v[72:75]
    ds_read_b128 v[136:139], v35 offset:4096
    ds_read_b128 v[140:143], v35 offset:6144
    v_mfma_f32_16x16x32_bf16 v[92:95], v[112:115], v[156:159], v[92:95]
    ds_read_b128 v[144:147], v35 offset:8192
    buffer_load_dwordx4 v33, s[8:11], s73 offen offset:2048 lds
    v_mfma_f32_16x16x32_bf16 v[56:59], v[148:151], v[116:119], v[56:59]
    s_mov_b64 exec, s[92:93]
    s_add_u32 m0, s48, 69632
    s_add_u32 s72, s45, s71
    buffer_load_dwordx4 v16, s[4:7], s72 offen lds
    s_mov_b64 exec, -1
    v_mfma_f32_16x16x32_bf16 v[76:79], v[152:155], v[116:119], v[76:79]
    s_add_u32 m0, s48, 70656
    s_add_u32 s72, s46, s71
    buffer_load_dwordx4 v16, s[4:7], s72 offen lds
    v_mfma_f32_16x16x32_bf16 v[96:99], v[116:119], v[156:159], v[96:99]
    s_mov_b64 exec, s[94:95]
    s_add_u32 m0, s49, 69632
    s_add_u32 s72, s47, s71
    buffer_load_dwordx4 v16, s[4:7], s72 offen lds
    s_mov_b64 exec, -1
    v_mfma_f32_16x16x32_bf16 v[60:63], v[148:151], v[120:123], v[60:63]
    v_mfma_f32_16x16x32_bf16 v[80:83], v[152:155], v[120:123], v[80:83]
    v_mfma_f32_16x16x32_bf16 v[100:103], v[120:123], v[156:159], v[100:103]
    v_mfma_f32_16x16x32_bf16 v[64:67], v[148:151], v[124:127], v[64:67]
    v_mfma_f32_16x16x32_bf16 v[84:87], v[152:155], v[124:127], v[84:87]
    v_mfma_f32_16x16x32_bf16 v[104:107], v[124:127], v[156:159], v[104:107]
    s_waitcnt vmcnt(9)
    s_waitcnt lgkmcnt(0)
    s_barrier
    s_cmp_eq_u32 s64, 0
    s_cselect_b64 exec, -1, 0
    buffer_load_dwordx4 v[244:247], v5, s[32:35], 0 offen sc1
    s_mov_b64 exec, -1
    v_mfma_f32_16x16x32_bf16 v[48:51], v[160:163], v[128:131], v[48:51]
    ds_read_b64_tr_b16 v[148:149], v36 offset:34816
    ds_read_b64_tr_b16 v[150:151], v36 offset:35328
    v_mfma_f32_16x16x32_bf16 v[68:71], v[164:167], v[128:131], v[68:71]
    ds_read_b64_tr_b16 v[152:153], v36 offset:35840
    ds_read_b64_tr_b16 v[154:155], v36 offset:36352
    v_mfma_f32_16x16x32_bf16 v[88:91], v[128:131], v[168:171], v[88:91]
    ds_read_b64_tr_b16 v[156:157], v36 offset:36864
    ds_read_b64_tr_b16 v[158:159], v36 offset:37376
    v_mfma_f32_16x16x32_bf16 v[52:55], v[160:163], v[132:135], v[52:55]
    ds_read_b128 v[108:111], v34 offset:34816
    ds_read_b128 v[112:115], v34 offset:36864
    v_mfma_f32_16x16x32_bf16 v[72:75], v[164:167], v[132:135], v[72:75]
    ds_read_b128 v[116:119], v34 offset:38912
    ds_read_b128 v[120:123], v34 offset:40960
    v_mfma_f32_16x16x32_bf16 v[92:95], v[132:135], v[168:171], v[92:95]
    ds_read_b128 v[124:127], v34 offset:43008
    v_mfma_f32_16x16x32_bf16 v[56:59], v[160:163], v[136:139], v[56:59]
    v_mfma_f32_16x16x32_bf16 v[76:79], v[164:167], v[136:139], v[76:79]
    s_add_u32 s71, s44, 6
    s_and_b32 s71, s71, 7
    s_mul_i32 s73, s71, 196608
    s_add_u32 s73, s73, s51
    s_lshl_b32 s71, s71, 7
    s_add_u32 m0, s50, 0
    s_nop 0
    buffer_load_dwordx4 v32, s[8:11], s73 offen lds
    v_mfma_f32_16x16x32_bf16 v[96:99], v[136:139], v[168:171], v[96:99]
    v_mfma_f32_16x16x32_bf16 v[60:63], v[160:163], v[140:143], v[60:63]
    buffer_load_dwordx4 v32, s[8:11], s73 offen offset:1024 lds
    v_mfma_f32_16x16x32_bf16 v[80:83], v[164:167], v[140:143], v[80:83]
    v_mfma_f32_16x16x32_bf16 v[100:103], v[140:143], v[168:171], v[100:103]
    buffer_load_dwordx4 v32, s[8:11], s73 offen offset:2048 lds
    v_mfma_f32_16x16x32_bf16 v[64:67], v[160:163], v[144:147], v[64:67]
    v_mfma_f32_16x16x32_bf16 v[84:87], v[164:167], v[144:147], v[84:87]
    s_add_u32 m0, s50, 3072
    s_nop 0
    buffer_load_dwordx4 v33, s[8:11], s73 offen offset:0 lds
    v_mfma_f32_16x16x32_bf16 v[104:107], v[144:147], v[168:171], v[104:107]
    buffer_load_dwordx4 v33, s[8:11], s73 offen offset:1024 lds
    s_waitcnt lgkmcnt(0)
    v_mfma_f32_16x16x32_bf16 v[48:51], v[148:151], v[108:111], v[48:51]
    ds_read_b64_tr_b16 v[160:161], v36 offset:47104
    ds_read_b64_tr_b16 v[162:163], v36 offset:47616
    v_mfma_f32_16x16x32_bf16 v[68:71], v[152:155], v[108:111], v[68:71]
    ds_read_b64_tr_b16 v[164:165], v36 offset:48128
    ds_read_b64_tr_b16 v[166:167], v36 offset:48640
    v_mfma_f32_16x16x32_bf16 v[88:91], v[108:111], v[156:159], v[88:91]
    ds_read_b64_tr_b16 v[168:169], v36 offset:49152
    ds_read_b64_tr_b16 v[170:171], v36 offset:49664
    v_mfma_f32_16x16x32_bf16 v[52:55], v[148:151], v[112:115], v[52:55]
    ds_read_b128 v[128:131], v35 offset:34816
    ds_read_b128 v[132:135], v35 offset:36864
    v_mfma_f32_16x16x32_bf16 v[72:75], v[152:155], v[112:115], v[72:75]
    ds_read_b128 v[136:139], v35 offset:38912
    ds_read_b128 v[140:143], v35 offset:40960
    v_mfma_f32_16x16x32_bf16 v[92:95], v[112:115], v[156:159], v[92:95]
    ds_read_b128 v[144:147], v35 offset:43008
    buffer_load_dwordx4 v33, s[8:11], s73 offen offset:2048 lds
    v_mfma_f32_16x16x32_bf16 v[56:59], v[148:151], v[116:119], v[56:59]
    s_mov_b64 exec, s[92:93]
    s_add_u32 m0, s48, 0
    s_add_u32 s72, s45, s71
    buffer_load_dwordx4 v16, s[4:7], s72 offen lds
    s_mov_b64 exec, -1
    v_mfma_f32_16x16x32_bf16 v[76:79], v[152:155], v[116:119], v[76:79]
    s_add_u32 m0, s48, 1024
    s_add_u32 s72, s46, s71
    buffer_load_dwordx4 v16, s[4:7], s72 offen lds
    v_mfma_f32_16x16x32_bf16 v[96:99], v[116:119], v[156:159], v[96:99]
    s_mov_b64 exec, s[94:95]
    s_add_u32 m0, s49, 0
    s_add_u32 s72, s47, s71
    buffer_load_dwordx4 v16, s[4:7], s72 offen lds
    s_mov_b64 exec, -1
    v_mfma_f32_16x16x32_bf16 v[60:63], v[148:151], v[120:123], v[60:63]
    v_mfma_f32_16x16x32_bf16 v[80:83], v[152:155], v[120:123], v[80:83]
    v_mfma_f32_16x16x32_bf16 v[100:103], v[120:123], v[156:159], v[100:103]
    v_mfma_f32_16x16x32_bf16 v[64:67], v[148:151], v[124:127], v[64:67]
    v_mfma_f32_16x16x32_bf16 v[84:87], v[152:155], v[124:127], v[84:87]
    v_mfma_f32_16x16x32_bf16 v[104:107], v[124:127], v[156:159], v[104:107]
    s_waitcnt vmcnt(9)
    s_nop 10
    s_cmp_eq_u32 s64, 0
    s_cbranch_scc0 L_skip2
    v_subrev_u32 v244, s76, v244
    v_subrev_u32 v245, s76, v245
    v_subrev_u32 v246, s76, v246
    v_subrev_u32 v247, s76, v247
    v_or_b32 v8, v244, v245
    v_or3_b32 v8, v8, v246, v247
    v_cmp_lt_u32 vcc, 15, v8
    s_nop 1
    s_and_b64 vcc, vcc, -1
    s_cbranch_scc0 L_go2
    s_mov_b32 s78, 0
L_wait2:
    s_sleep 2
    buffer_load_dwordx4 v[244:247], v5, s[32:35], 0 offen sc1
    s_waitcnt vmcnt(0)
    v_subrev_u32 v244, s76, v244
    v_subrev_u32 v245, s76, v245
    v_subrev_u32 v246, s76, v246
    v_subrev_u32 v247, s76, v247
    v_or_b32 v8, v244, v245
    v_or3_b32 v8, v8, v246, v247
    v_cmp_lt_u32 vcc, 15, v8
    s_nop 1
    s_and_b64 vcc, vcc, -1
    s_cbranch_scc0 L_go2
    s_add_u32 s78, s78, 1
    s_cmp_lt_u32 s78, 0x20000
    s_cbranch_scc1 L_wait2
L_go2:
    s_nop 1
    v_xor_b32 v244, s3, v244
    v_xor_b32 v245, s3, v245
    v_xor_b32 v246, s3, v246
    v_xor_b32 v247, s3, v247
    v_or_b32 v8, v244, v245
    v_or3_b32 v8, v8, v246, v247
    v_cmp_ne_u32 vcc, 0, v8
    s_lshl_b32 s74, s65, 2
    s_nop 0
    s_lshr_b64 vcc, vcc, s74
    s_and_b32 s74, vcc_lo, 15
    s_cmp_eq_u32 s74, 0
    s_cselect_b32 s74, 1, 0
    v_mov_b32 v8, s74
    v_mov_b32 v9, 155648
    ds_write_b32 v9, v8
L_skip2:
    s_nop 3
    s_waitcnt lgkmcnt(0)
    s_barrier
    v_mov_b32 v9, 155648
    ds_read_b32 v10, v9
    v_mfma_f32_16x16x32_bf16 v[48:51], v[160:163], v[128:131], v[48:51]
    ds_read_b64_tr_b16 v[148:149], v39 offset:0
    ds_read_b64_tr_b16 v[150:151], v39 offset:512
    v_mfma_f32_16x16x32_bf16 v[68:71], v[164:167], v[128:131], v[68:71]
    ds_read_b64_tr_b16 v[152:153], v39 offset:1024
    ds_read_b64_tr_b16 v[154:155], v39 offset:1536
    v_mfma_f32_16x16x32_bf16 v[88:91], v[128:131], v[168:171], v[88:91]
    ds_read_b64_tr_b16 v[156:157], v39 offset:2048
    ds_read_b64_tr_b16 v[158:159], v39 offset:2560
    v_mfma_f32_16x16x32_bf16 v[52:55], v[160:163], v[132:135], v[52:55]
    ds_read_b128 v[108:111], v37 offset:0
    ds_read_b128 v[112:115], v37 offset:2048
    v_mfma_f32_16x16x32_bf16 v[72:75], v[164:167], v[132:135], v[72:75]
    ds_read_b128 v[116:119], v37 offset:4096
    ds_read_b128 v[120:123], v37 offset:6144
    v_mfma_f32_16x16x32_bf16 v[92:95], v[132:135], v[168:171], v[92:95]
    ds_read_b128 v[124:127], v37 offset:8192
    v_mfma_f32_16x16x32_bf16 v[56:59], v[160:163], v[136:139], v[56:59]
    v_mfma_f32_16x16x32_bf16 v[76:79], v[164:167], v[136:139], v[76:79]
    s_add_u32 s71, s44, 7
    s_and_b32 s71, s71, 7
    s_mul_i32 s73, s71, 196608
    s_add_u32 s73, s73, s51
    s_lshl_b32 s71, s71, 7
    s_add_u32 m0, s50, 34816
    s_nop 0
    buffer_load_dwordx4 v32, s[8:11], s73 offen lds
    v_mfma_f32_16x16x32_bf16 v[96:99], v[136:139], v[168:171], v[96:99]
    v_mfma_f32_16x16x32_bf16 v[60:63], v[160:163], v[140:143], v[60:63]
    buffer_load_dwordx4 v32, s[8:11], s73 offen offset:1024 lds
    v_mfma_f32_16x16x32_bf16 v[80:83], v[164:167], v[140:143], v[80:83]
    v_mfma_f32_16x16x32_bf16 v[100:103], v[140:143], v[168:171], v[100:103]
    buffer_load_dwordx4 v32, s[8:11], s73 offen offset:2048 lds
    v_mfma_f32_16x16x32_bf16 v[64:67], v[160:163], v[144:147], v[64:67]
    v_mfma_f32_16x16x32_bf16 v[84:87], v[164:167], v[144:147], v[84:87]
    s_add_u32 m0, s50, 37888
    s_nop 0
    buffer_load_dwordx4 v33, s[8:11], s73 offen offset:0 lds
    v_mfma_f32_16x16x32_bf16 v[104:107], v[144:147], v[168:171], v[104:107]
    buffer_load_dwordx4 v33, s[8:11], s73 offen offset:1024 lds
    s_waitcnt lgkmcnt(0)
    v_readfirstlane_b32 s75, v10
    v_mfma_f32_16x16x32_bf16 v[48:51], v[148:151], v[108:111], v[48:51]
    ds_read_b64_tr_b16 v[160:161], v39 offset:12288
    ds_read_b64_tr_b16 v[162:163], v39 offset:12800
    v_mfma_f32_16x16x32_bf16 v[68:71], v[152:155], v[108:111], v[68:71]
    ds_read_b64_tr_b16 v[164:165], v39 offset:13312
    ds_read_b64_tr_b16 v[166:167], v39 offset:13824
    v_mfma_f32_16x16x32_bf16 v[88:91], v[108:111], v[156:159], v[88:91]
    ds_read_b64_tr_b16 v[168:169], v39 offset:14336
    ds_read_b64_tr_b16 v[170:171], v39 offset:14848
    v_mfma_f32_16x16x32_bf16 v[52:55], v[148:151], v[112:115], v[52:55]
    ds_read_b128 v[128:131], v38 offset:0
    ds_read_b128 v[132:135], v38 offset:2048
    v_mfma_f32_16x16x32_bf16 v[72:75], v[152:155], v[112:115], v[72:75]
    ds_read_b128 v[136:139], v38 offset:4096
    ds_read_b128 v[140:143], v38 offset:6144
    v_mfma_f32_16x16x32_bf16 v[92:95], v[112:115], v[156:159], v[92:95]
    ds_read_b128 v[144:147], v38 offset:8192
    buffer_load_dwordx4 v33, s[8:11], s73 offen offset:2048 lds
    v_mfma_f32_16x16x32_bf16 v[56:59], v[148:151], v[116:119], v[56:59]
    s_mov_b64 exec, s[92:93]
    s_add_u32 m0, s48, 34816
    s_add_u32 s72, s45, s71
    buffer_load_dwordx4 v16, s[4:7], s72 offen lds
    s_mov_b64 exec, -1
    v_mfma_f32_16x16x32_bf16 v[76:79], v[152:155], v[116:119], v[76:79]
    s_add_u32 m0, s48, 35840
    s_add_u32 s72, s46, s71
    buffer_load_dwordx4 v16, s[4:7], s72 offen lds
    v_mfma_f32_16x16x32_bf16 v[96:99], v[116:119], v[156:159], v[96:99]
    s_mov_b64 exec, s[94:95]
    s_add_u32 m0, s49, 34816
    s_add_u32 s72, s47, s71
    buffer_load_dwordx4 v16, s[4:7], s72 offen lds
    s_mov_b64 exec, -1
    v_mfma_f32_16x16x32_bf16 v[60:63], v[148:151], v[120:123], v[60:63]
    s_lshl_b32 s74, s63, 2
    s_add_u32 s74, s74, 24641536
    s_lshl_b32 m0, s64, 8
    s_add_u32 m0, m0, 153600
    s_nop 0
    buffer_load_dword v42, s[32:35], s74 offen lds
    v_mfma_f32_16x16x32_bf16 v[80:83], v[152:155], v[120:123], v[80:83]
    s_add_u32 s74, s12, 0
    buffer_load_dwordx4 a[192:195], v4, s[32:35], s74 offen offset:0
    v_mfma_f32_16x16x32_bf16 v[100:103], v[120:123], v[156:159], v[100:103]
    s_add_u32 s74, s12, 0
    buffer_load_dwordx4 a[196:199], v4, s[32:35], s74 offen offset:1024
    v_mfma_f32_16x16x32_bf16 v[64:67], v[148:151], v[124:127], v[64:67]
    s_add_u32 s74, s13, 0
    buffer_load_dwordx4 a[200:203], v4, s[32:35], s74 offen offset:0
    v_mfma_f32_16x16x32_bf16 v[84:87], v[152:155], v[124:127], v[84:87]
    s_add_u32 s74, s13, 0
    buffer_load_dwordx4 a[204:207], v4, s[32:35], s74 offen offset:1024
    v_mfma_f32_16x16x32_bf16 v[104:107], v[124:127], v[156:159], v[104:107]
    s_add_u32 s74, s12, 4096
    buffer_load_dwordx4 a[208:211], v4, s[32:35], s74 offen offset:0
    s_add_u32 s74, s12, 4096
    buffer_load_dwordx4 a[212:215], v4, s[32:35], s74 offen offset:1024
    s_add_u32 s74, s13, 4096
    buffer_load_dwordx4 a[216:219], v4, s[32:35], s74 offen offset:0
    s_add_u32 s74, s13, 4096
    buffer_load_dwordx4 a[220:223], v4, s[32:35], s74 offen offset:1024
    s_waitcnt vmcnt(18)
    s_waitcnt lgkmcnt(0)
    s_barrier
    v_mfma_f32_16x16x32_bf16 v[48:51], v[160:163], v[128:131], v[48:51]
    ds_read_b64_tr_b16 v[148:149], v36 offset:0
    ds_read_b64_tr_b16 v[150:151], v36 offset:512
    v_mfma_f32_16x16x32_bf16 v[68:71], v[164:167], v[128:131], v[68:71]
    ds_read_b64_tr_b16 v[152:153], v36 offset:1024
    ds_read_b64_tr_b16 v[154:155], v36 offset:1536
    v_mfma_f32_16x16x32_bf16 v[88:91], v[128:131], v[168:171], v[88:91]
    ds_read_b64_tr_b16 v[156:157], v36 offset:2048
    ds_read_b64_tr_b16 v[158:159], v36 offset:2560
    v_mfma_f32_16x16x32_bf16 v[52:55], v[160:163], v[132:135], v[52:55]
    ds_read_b128 v[108:111], v34 offset:0
    ds_read_b128 v[112:115], v34 offset:2048
    v_mfma_f32_16x16x32_bf16 v[72:75], v[164:167], v[132:135], v[72:75]
    ds_read_b128 v[116:119], v34 offset:4096
    ds_read_b128 v[120:123], v34 offset:6144
    v_mfma_f32_16x16x32_bf16 v[92:95], v[132:135], v[168:171], v[92:95]
    ds_read_b128 v[124:127], v34 offset:8192
    v_mfma_f32_16x16x32_bf16 v[56:59], v[160:163], v[136:139], v[56:59]
    v_mfma_f32_16x16x32_bf16 v[76:79], v[164:167], v[136:139], v[76:79]
    v_mfma_f32_16x16x32_bf16 v[96:99], v[136:139], v[168:171], v[96:99]
    v_mfma_f32_16x16x32_bf16 v[60:63], v[160:163], v[140:143], v[60:63]
    v_mfma_f32_16x16x32_bf16 v[80:83], v[164:167], v[140:143], v[80:83]
    v_mfma_f32_16x16x32_bf16 v[100:103], v[140:143], v[168:171], v[100:103]
    v_mfma_f32_16x16x32_bf16 v[64:67], v[160:163], v[144:147], v[64:67]
    v_mfma_f32_16x16x32_bf16 v[84:87], v[164:167], v[144:147], v[84:87]
    v_mfma_f32_16x16x32_bf16 v[104:107], v[144:147], v[168:171], v[104:107]
    s_waitcnt lgkmcnt(0)
    v_mfma_f32_16x16x32_bf16 v[48:51], v[148:151], v[108:111], v[48:51]
    ds_read_b64_tr_b16 v[160:161], v36 offset:12288
    ds_read_b64_tr_b16 v[162:163], v36 offset:12800
    v_mfma_f32_16x16x32_bf16 v[68:71], v[152:155], v[108:111], v[68:71]
    ds_read_b64_tr_b16 v[164:165], v36 offset:13312
    ds_read_b64_tr_b16 v[166:167], v36 offset:13824
    v_mfma_f32_16x16x32_bf16 v[88:91], v[108:111], v[156:159], v[88:91]
    ds_read_b64_tr_b16 v[168:169], v36 offset:14336
    ds_read_b64_tr_b16 v[170:171], v36 offset:14848
    v_mfma_f32_16x16x32_bf16 v[52:55], v[148:151], v[112:115], v[52:55]
    ds_read_b128 v[128:131], v35 offset:0
    ds_read_b128 v[132:135], v35 offset:2048
    v_mfma_f32_16x16x32_bf16 v[72:75], v[152:155], v[112:115], v[72:75]
    ds_read_b128 v[136:139], v35 offset:4096
    ds_read_b128 v[140:143], v35 offset:6144
    v_mfma_f32_16x16x32_bf16 v[92:95], v[112:115], v[156:159], v[92:95]
    ds_read_b128 v[144:147], v35 offset:8192
    s_add_u32 s74, s12, 8192
    buffer_load_dwordx4 a[224:227], v4, s[32:35], s74 offen offset:0
    v_mfma_f32_16x16x32_bf16 v[56:59], v[148:151], v[116:119], v[56:59]
    s_add_u32 s74, s12, 8192
    buffer_load_dwordx4 a[228:231], v4, s[32:35], s74 offen offset:1024
    v_mfma_f32_16x16x32_bf16 v[76:79], v[152:155], v[116:119], v[76:79]
    s_add_u32 s74, s13, 8192
    buffer_load_dwordx4 a[232:235], v4, s[32:35], s74 offen offset:0
    v_mfma_f32_16x16x32_bf16 v[96:99], v[116:119], v[156:159], v[96:99]
    s_add_u32 s74, s13, 8192
    buffer_load_dwordx4 a[236:239], v4, s[32:35], s74 offen offset:1024
    v_mfma_f32_16x16x32_bf16 v[60:63], v[148:151], v[120:123], v[60:63]
    s_add_u32 s74, s12, 12288
    buffer_load_dwordx4 a[240:243], v4, s[32:35], s74 offen offset:0
    v_mfma_f32_16x16x32_bf16 v[80:83], v[152:155], v[120:123], v[80:83]
    s_add_u32 s74, s12, 12288
    buffer_load_dwordx4 a[244:247], v4, s[32:35], s74 offen offset:1024
    v_mfma_f32_16x16x32_bf16 v[100:103], v[120:123], v[156:159], v[100:103]
    s_add_u32 s74, s13, 12288
    buffer_load_dwordx4 a[248:251], v4, s[32:35], s74 offen offset:0
    v_mfma_f32_16x16x32_bf16 v[64:67], v[148:151], v[124:127], v[64:67]
    s_add_u32 s74, s13, 12288
    buffer_load_dwordx4 a[252:255], v4, s[32:35], s74 offen offset:1024
    v_mfma_f32_16x16x32_bf16 v[84:87], v[152:155], v[124:127], v[84:87]
    v_mfma_f32_16x16x32_bf16 v[104:107], v[124:127], v[156:159], v[104:107]
    s_waitcnt vmcnt(17)
    s_waitcnt lgkmcnt(0)
    s_barrier
    v_mfma_f32_16x16x32_bf16 v[48:51], v[160:163], v[128:131], v[48:51]
    ds_read_b64_tr_b16 v[148:149], v36 offset:34816
    ds_read_b64_tr_b16 v[150:151], v36 offset:35328
    v_mfma_f32_16x16x32_bf16 v[68:71], v[164:167], v[128:131], v[68:71]
    ds_read_b64_tr_b16 v[152:153], v36 offset:35840
    ds_read_b64_tr_b16 v[154:155], v36 offset:36352
    v_mfma_f32_16x16x32_bf16 v[88:91], v[128:131], v[168:171], v[88:91]
    ds_read_b64_tr_b16 v[156:157], v36 offset:36864
    ds_read_b64_tr_b16 v[158:159], v36 offset:37376
    v_mfma_f32_16x16x32_bf16 v[52:55], v[160:163], v[132:135], v[52:55]
    ds_read_b128 v[108:111], v34 offset:34816
    ds_read_b128 v[112:115], v34 offset:36864
    v_mfma_f32_16x16x32_bf16 v[72:75], v[164:167], v[132:135], v[72:75]
    ds_read_b128 v[116:119], v34 offset:38912
    ds_read_b128 v[120:123], v34 offset:40960
    v_mfma_f32_16x16x32_bf16 v[92:95], v[132:135], v[168:171], v[92:95]
    ds_read_b128 v[124:127], v34 offset:43008
    v_mfma_f32_16x16x32_bf16 v[56:59], v[160:163], v[136:139], v[56:59]
    v_mfma_f32_16x16x32_bf16 v[76:79], v[164:167], v[136:139], v[76:79]
    v_mfma_f32_16x16x32_bf16 v[96:99], v[136:139], v[168:171], v[96:99]
    v_mfma_f32_16x16x32_bf16 v[60:63], v[160:163], v[140:143], v[60:63]
    v_mfma_f32_16x16x32_bf16 v[80:83], v[164:167], v[140:143], v[80:83]
    v_mfma_f32_16x16x32_bf16 v[100:103], v[140:143], v[168:171], v[100:103]
    v_mfma_f32_16x16x32_bf16 v[64:67], v[160:163], v[144:147], v[64:67]
    v_mfma_f32_16x16x32_bf16 v[84:87], v[164:167], v[144:147], v[84:87]
    v_mfma_f32_16x16x32_bf16 v[104:107], v[144:147], v[168:171], v[104:107]
    s_waitcnt lgkmcnt(0)
    v_mfma_f32_16x16x32_bf16 v[48:51], v[148:151], v[108:111], v[48:51]
    ds_read_b64_tr_b16 v[160:161], v36 offset:47104
    ds_read_b64_tr_b16 v[162:163], v36 offset:47616
    v_mfma_f32_16x16x32_bf16 v[68:71], v[152:155], v[108:111], v[68:71]
    ds_read_b64_tr_b16 v[164:165], v36 offset:48128
    ds_read_b64_tr_b16 v[166:167], v36 offset:48640
    v_mfma_f32_16x16x32_bf16 v[88:91], v[108:111], v[156:159], v[88:91]
    ds_read_b64_tr_b16 v[168:169], v36 offset:49152
    ds_read_b64_tr_b16 v[170:171], v36 offset:49664
    v_mfma_f32_16x16x32_bf16 v[52:55], v[148:151], v[112:115], v[52:55]
    ds_read_b128 v[128:131], v35 offset:34816
    ds_read_b128 v[132:135], v35 offset:36864
    v_mfma_f32_16x16x32_bf16 v[72:75], v[152:155], v[112:115], v[72:75]
    ds_read_b128 v[136:139], v35 offset:38912
    ds_read_b128 v[140:143], v35 offset:40960
    v_mfma_f32_16x16x32_bf16 v[92:95], v[112:115], v[156:159], v[92:95]
    ds_read_b128 v[144:147], v35 offset:43008
    s_add_u32 s74, s80, 0
    buffer_load_dwordx4 a[0:3], v4, s[32:35], s74 offen offset:0
    v_mfma_f32_16x16x32_bf16 v[56:59], v[148:151], v[116:119], v[56:59]
    s_add_u32 s74, s80, 0
    buffer_load_dwordx4 a[4:7], v4, s[32:35], s74 offen offset:1024
    v_mfma_f32_16x16x32_bf16 v[76:79], v[152:155], v[116:119], v[76:79]
    s_add_u32 s74, s80, 0
    buffer_load_dwordx4 a[8:11], v4, s[32:35], s74 offen offset:2048
    v_mfma_f32_16x16x32_bf16 v[96:99], v[116:119], v[156:159], v[96:99]
    s_add_u32 s74, s80, 0
    buffer_load_dwordx4 a[12:15], v4, s[32:35], s74 offen offset:3072
    v_mfma_f32_16x16x32_bf16 v[60:63], v[148:151], v[120:123], v[60:63]
    s_add_u32 s74, s80, 4096
    buffer_load_dwordx4 a[16:19], v4, s[32:35], s74 offen offset:0
    v_mfma_f32_16x16x32_bf16 v[80:83], v[152:155], v[120:123], v[80:83]
    s_add_u32 s74, s80, 4096
    buffer_load_dwordx4 a[20:23], v4, s[32:35], s74 offen offset:1024
    v_mfma_f32_16x16x32_bf16 v[100:103], v[120:123], v[156:159], v[100:103]
    s_add_u32 s74, s80, 4096
    buffer_load_dwordx4 a[24:27], v4, s[32:35], s74 offen offset:2048
    v_mfma_f32_16x16x32_bf16 v[64:67], v[148:151], v[124:127], v[64:67]
    s_add_u32 s74, s80, 4096
    buffer_load_dwordx4 a[28:31], v4, s[32:35], s74 offen offset:3072
    v_mfma_f32_16x16x32_bf16 v[84:87], v[152:155], v[124:127], v[84:87]
    v_mfma_f32_16x16x32_bf16 v[104:107], v[124:127], v[156:159], v[104:107]
    s_waitcnt lgkmcnt(0)
    v_mfma_f32_16x16x32_bf16 v[48:51], v[160:163], v[128:131], v[48:51]
    v_mfma_f32_16x16x32_bf16 v[68:71], v[164:167], v[128:131], v[68:71]
    v_mfma_f32_16x16x32_bf16 v[88:91], v[128:131], v[168:171], v[88:91]
    v_mfma_f32_16x16x32_bf16 v[52:55], v[160:163], v[132:135], v[52:55]
    v_mfma_f32_16x16x32_bf16 v[72:75], v[164:167], v[132:135], v[72:75]
    v_mfma_f32_16x16x32_bf16 v[92:95], v[132:135], v[168:171], v[92:95]
    v_mfma_f32_16x16x32_bf16 v[56:59], v[160:163], v[136:139], v[56:59]
    v_mfma_f32_16x16x32_bf16 v[76:79], v[164:167], v[136:139], v[76:79]
    v_mfma_f32_16x16x32_bf16 v[96:99], v[136:139], v[168:171], v[96:99]
    v_mfma_f32_16x16x32_bf16 v[60:63], v[160:163], v[140:143], v[60:63]
    v_mfma_f32_16x16x32_bf16 v[80:83], v[164:167], v[140:143], v[80:83]
    v_mfma_f32_16x16x32_bf16 v[100:103], v[140:143], v[168:171], v[100:103]
    v_mfma_f32_16x16x32_bf16 v[64:67], v[160:163], v[144:147], v[64:67]
    v_mfma_f32_16x16x32_bf16 v[84:87], v[164:167], v[144:147], v[84:87]
    v_mfma_f32_16x16x32_bf16 v[104:107], v[144:147], v[168:171], v[104:107]
    s_waitcnt vmcnt(24)
    s_barrier
    ds_read2_b32 v[108:109], v40 offset0:0 offset1:128
    ds_read2_b32 v[110:111], v40 offset0:16 offset1:144
    ds_read2_b32 v[112:113], v40 offset0:32 offset1:160
    ds_read2_b32 v[114:115], v40 offset0:48 offset1:176
    ds_read2_b32 v[116:117], v40 offset0:64 offset1:192
    v_lshlrev_b32 v8, 2, v2
    ds_bpermute_b32 v168, v8, v88
    ds_read_b128 v[120:123], v41 offset:0
    ds_read_b128 v[140:143], v41 offset:512
    ds_read_b128 v[124:127], v41 offset:64
    ds_read_b128 v[144:147], v41 offset:576
    ds_read_b128 v[128:131], v41 offset:128
    ds_read_b128 v[148:151], v41 offset:640
    ds_read_b128 v[132:135], v41 offset:192
    ds_read_b128 v[152:155], v41 offset:704
    ds_read_b128 v[136:139], v41 offset:256
    ds_read_b128 v[156:159], v41 offset:768
    v_mov_b32_dpp v160, v48 row_newbcast:0 row_mask:0xf bank_mask:0xf
    v_mov_b32_dpp v164, v68 row_newbcast:0 row_mask:0xf bank_mask:0xf
    v_mov_b32_dpp v161, v49 row_newbcast:0 row_mask:0xf bank_mask:0xf
    v_mov_b32_dpp v165, v69 row_newbcast:0 row_mask:0xf bank_mask:0xf
    v_mov_b32_dpp v162, v50 row_newbcast:0 row_mask:0xf bank_mask:0xf
    v_mov_b32_dpp v166, v70 row_newbcast:0 row_mask:0xf bank_mask:0xf
    v_mov_b32_dpp v163, v51 row_newbcast:0 row_mask:0xf bank_mask:0xf
    v_mov_b32_dpp v167, v71 row_newbcast:0 row_mask:0xf bank_mask:0xf
    s_lshl_b32 s73, s69, 16
    s_lshl_b32 s72, s68, 11
    s_add_u32 s73, s73, s72
    s_lshl_b32 s72, s64, 9
    s_add_u32 s73, s73, s72
    s_add_u32 s73, s73, 1048576
    s_waitcnt lgkmcnt(10)
    v_pk_fma_f32 v[68:69], v[164:165], v[108:109], v[68:69] op_sel:[0,0,0] op_sel_hi:[1,0,1] neg_lo:[0,1,0] neg_hi:[0,1,0]
    v_pk_fma_f32 v[70:71], v[166:167], v[108:109], v[70:71] op_sel:[0,0,0] op_sel_hi:[1,0,1] neg_lo:[0,1,0] neg_hi:[0,1,0]
    v_pk_mul_f32 v[68:69], v[68:69], v[108:109] op_sel:[0,1] op_sel_hi:[1,1]
    v_pk_mul_f32 v[70:71], v[70:71], v[108:109] op_sel:[0,1] op_sel_hi:[1,1]
    v_cvt_pk_bf16_f32 v210, v68, v69
    v_cvt_pk_bf16_f32 v211, v70, v71
    v_pk_fma_f32 v[72:73], v[164:165], v[110:111], v[72:73] op_sel:[0,0,0] op_sel_hi:[1,0,1] neg_lo:[0,1,0] neg_hi:[0,1,0]
    v_pk_fma_f32 v[74:75], v[166:167], v[110:111], v[74:75] op_sel:[0,0,0] op_sel_hi:[1,0,1] neg_lo:[0,1,0] neg_hi:[0,1,0]
    v_pk_mul_f32 v[72:73], v[72:73], v[110:111] op_sel:[0,1] op_sel_hi:[1,1]
    v_pk_mul_f32 v[74:75], v[74:75], v[110:111] op_sel:[0,1] op_sel_hi:[1,1]
    v_cvt_pk_bf16_f32 v212, v72, v73
    v_cvt_pk_bf16_f32 v213, v74, v75
    v_pk_fma_f32 v[76:77], v[164:165], v[112:113], v[76:77] op_sel:[0,0,0] op_sel_hi:[1,0,1] neg_lo:[0,1,0] neg_hi:[0,1,0]
    v_pk_fma_f32 v[78:79], v[166:167], v[112:113], v[78:79] op_sel:[0,0,0] op_sel_hi:[1,0,1] neg_lo:[0,1,0] neg_hi:[0,1,0]
    v_pk_mul_f32 v[76:77], v[76:77], v[112:113] op_sel:[0,1] op_sel_hi:[1,1]
    v_pk_mul_f32 v[78:79], v[78:79], v[112:113] op_sel:[0,1] op_sel_hi:[1,1]
    v_cvt_pk_bf16_f32 v214, v76, v77
    v_cvt_pk_bf16_f32 v215, v78, v79
    v_pk_fma_f32 v[52:53], v[160:161], v[110:111], v[52:53] op_sel:[0,0,0] op_sel_hi:[1,0,1] neg_lo:[0,1,0] neg_hi:[0,1,0]
    v_pk_fma_f32 v[54:55], v[162:163], v[110:111], v[54:55] op_sel:[0,0,0] op_sel_hi:[1,0,1] neg_lo:[0,1,0] neg_hi:[0,1,0]
    v_cvt_pk_bf16_f32 v222, v52, v53
    v_cvt_pk_bf16_f32 v223, v54, v55
    v_pk_fma_f32 v[56:57], v[160:161], v[112:113], v[56:57] op_sel:[0,0,0] op_sel_hi:[1,0,1] neg_lo:[0,1,0] neg_hi:[0,1,0]
    v_pk_fma_f32 v[58:59], v[162:163], v[112:113], v[58:59] op_sel:[0,0,0] op_sel_hi:[1,0,1] neg_lo:[0,1,0] neg_hi:[0,1,0]
    v_cvt_pk_bf16_f32 v224, v56, v57
    v_cvt_pk_bf16_f32 v225, v58, v59
    v_mfma_f32_16x16x16_bf16 v[172:175], v[210:211], v[222:223], v[204:207]
    v_mfma_f32_16x16x16_bf16 v[176:179], v[212:213], v[222:223], v[200:203]
    v_mfma_f32_16x16x16_bf16 v[180:183], v[212:213], v[224:225], v[196:199]
    v_mfma_f32_16x16x16_bf16 v[184:187], v[214:215], v[224:225], v[200:203]
    s_waitcnt lgkmcnt(0)
    v_pk_fma_f32 v[88:89], v[120:121], v[168:169], v[88:89] op_sel:[0,0,0] op_sel_hi:[1,0,1] neg_lo:[1,0,0] neg_hi:[1,0,0]
    v_pk_fma_f32 v[90:91], v[122:123], v[168:169], v[90:91] op_sel:[0,0,0] op_sel_hi:[1,0,1] neg_lo:[1,0,0] neg_hi:[1,0,0]
    v_pk_mul_f32 v[88:89], v[88:89], v[140:141]
    v_pk_mul_f32 v[90:91], v[90:91], v[142:143]
    v_cvt_pk_bf16_f32 v230, v88, v89
    v_cvt_pk_bf16_f32 v231, v90, v91
    v_pk_fma_f32 v[92:93], v[124:125], v[168:169], v[92:93] op_sel:[0,0,0] op_sel_hi:[1,0,1] neg_lo:[1,0,0] neg_hi:[1,0,0]
    v_pk_fma_f32 v[94:95], v[126:127], v[168:169], v[94:95] op_sel:[0,0,0] op_sel_hi:[1,0,1] neg_lo:[1,0,0] neg_hi:[1,0,0]
    v_pk_mul_f32 v[92:93], v[92:93], v[144:145]
    v_pk_mul_f32 v[94:95], v[94:95], v[146:147]
    v_cvt_pk_bf16_f32 v232, v92, v93
    v_cvt_pk_bf16_f32 v233, v94, v95
    v_pk_fma_f32 v[96:97], v[128:129], v[168:169], v[96:97] op_sel:[0,0,0] op_sel_hi:[1,0,1] neg_lo:[1,0,0] neg_hi:[1,0,0]
    v_pk_fma_f32 v[98:99], v[130:131], v[168:169], v[98:99] op_sel:[0,0,0] op_sel_hi:[1,0,1] neg_lo:[1,0,0] neg_hi:[1,0,0]
    v_pk_mul_f32 v[96:97], v[96:97], v[148:149]
    v_pk_mul_f32 v[98:99], v[98:99], v[150:151]
    s_load_dword s20, s[18:19], 24576
    v_cvt_pk_bf16_f32 v234, v96, v97
    v_cvt_pk_bf16_f32 v235, v98, v99
    v_mul_f32 v192, 0x3eb8aa3b, v111
    v_mul_f32 v193, 0x3eb8aa3b, v113
    v_max_f32 v240, v172, v173
    v_max_f32 v241, v174, v175
    v_max_f32 v242, v176, v177
    v_max_f32 v243, v178, v179
    v_max3_f32 v188, v240, v241, v242
    v_max_f32 v188, v188, v243
    v_mov_b32 v190, v188
    v_max_f32 v244, v180, v181
    v_max_f32 v245, v182, v183
    v_max_f32 v246, v184, v185
    v_max_f32 v247, v186, v187
    v_max3_f32 v189, v244, v245, v246
    s_load_dword s20, s[18:19], 24704
    v_max_f32 v189, v189, v247
    v_mov_b32 v191, v189
    v_permlane16_swap_b32 v188, v190
    s_nop 0
    v_permlane16_swap_b32 v189, v191
    v_max_f32 v188, v188, v190
    v_max_f32 v189, v189, v191
    v_mov_b32 v190, v188
    v_mov_b32 v191, v189
    s_nop 0
    v_permlane32_swap_b32 v188, v190
    v_permlane32_swap_b32 v189, v191
    v_max_f32 v188, v188, v190
    v_max_f32 v189, v189, v191
    v_mul_f32 v188, v188, v192
    v_mul_f32 v189, v189, v193
    v_fma_f32 v240, v240, v192, -v188
    v_fma_f32 v241, v241, v192, -v188
    s_load_dword s20, s[18:19], 24832
    v_fma_f32 v242, v242, v192, -v188
    v_fma_f32 v243, v243, v192, -v188
    v_fma_f32 v244, v244, v193, -v189
    v_fma_f32 v245, v245, v193, -v189
    v_fma_f32 v246, v246, v193, -v189
    v_fma_f32 v247, v247, v193, -v189
    v_exp_f32 v240, v240
    v_exp_f32 v241, v241
    v_exp_f32 v242, v242
    v_exp_f32 v243, v243
    v_exp_f32 v244, v244
    v_exp_f32 v245, v245
    v_exp_f32 v246, v246
    v_exp_f32 v247, v247
    v_cvt_pk_bf16_f32 v188, v240, v241
    v_cvt_pk_bf16_f32 v190, v242, v243
    s_load_dword s20, s[18:19], 24960
    v_cvt_pk_bf16_f32 v189, v244, v245
    v_cvt_pk_bf16_f32 v191, v246, v247
    v_perm_b32 v172, v188, v188, v208
    v_perm_b32 v173, v188, v188, v209
    v_perm_b32 v174, v190, v190, v208
    v_perm_b32 v175, v190, v190, v209
    v_perm_b32 v176, v189, v189, v208
    v_perm_b32 v177, v189, v189, v209
    v_perm_b32 v178, v191, v191, v208
    v_perm_b32 v179, v191, v191, v209
    v_mfma_f32_16x16x32_bf16 v[240:243], v[28:31], v[172:175], 0
    v_mfma_f32_16x16x32_bf16 v[180:183], v[230:233], v[172:175], 0
    v_mfma_f32_16x16x32_bf16 v[244:247], v[28:31], v[176:179], 0
    v_mfma_f32_16x16x32_bf16 v[184:187], v[232:235], v[176:179], 0
    s_nop 4
    v_rcp_f32 v240, v240
    s_nop 0
    v_rcp_f32 v244, v244
    v_pk_mul_f32 v[180:181], v[180:181], v[240:241] op_sel:[0,0] op_sel_hi:[1,0]
    v_pk_mul_f32 v[182:183], v[182:183], v[240:241] op_sel:[0,0] op_sel_hi:[1,0]
    v_cvt_pk_bf16_f32 v248, v180, v181
    v_cvt_pk_bf16_f32 v249, v182, v183
    s_load_dword s20, s[18:19], 25088
    v_pk_mul_f32 v[184:185], v[184:185], v[244:245] op_sel:[0,0] op_sel_hi:[1,0]
    v_pk_mul_f32 v[186:187], v[186:187], v[244:245] op_sel:[0,0] op_sel_hi:[1,0]
    v_cvt_pk_bf16_f32 v250, v184, v185
    v_cvt_pk_bf16_f32 v251, v186, v187
    s_nop 0
    v_permlane16_swap_b32 v248, v250
    v_permlane16_swap_b32 v249, v251
    s_add_u32 s72, s73, 0
    buffer_store_dwordx4 v[248:251], v43, s[32:35], s72 offen sc1
    v_pk_fma_f32 v[80:81], v[164:165], v[114:115], v[80:81] op_sel:[0,0,0] op_sel_hi:[1,0,1] neg_lo:[0,1,0] neg_hi:[0,1,0]
    v_pk_fma_f32 v[82:83], v[166:167], v[114:115], v[82:83] op_sel:[0,0,0] op_sel_hi:[1,0,1] neg_lo:[0,1,0] neg_hi:[0,1,0]
    v_pk_mul_f32 v[80:81], v[80:81], v[114:115] op_sel:[0,1] op_sel_hi:[1,1]
    v_pk_mul_f32 v[82:83], v[82:83], v[114:115] op_sel:[0,1] op_sel_hi:[1,1]
    v_cvt_pk_bf16_f32 v216, v80, v81
    v_cvt_pk_bf16_f32 v217, v82, v83
    v_pk_fma_f32 v[84:85], v[164:165], v[116:117], v[84:85] op_sel:[0,0,0] op_sel_hi:[1,0,1] neg_lo:[0,1,0] neg_hi:[0,1,0]
    v_pk_fma_f32 v[86:87], v[166:167], v[116:117], v[86:87] op_sel:[0,0,0] op_sel_hi:[1,0,1] neg_lo:[0,1,0] neg_hi:[0,1,0]
    v_pk_mul_f32 v[84:85], v[84:85], v[116:117] op_sel:[0,1] op_sel_hi:[1,1]
    v_pk_mul_f32 v[86:87], v[86:87], v[116:117] op_sel:[0,1] op_sel_hi:[1,1]
    s_load_dword s20, s[18:19], 25216
    v_cvt_pk_bf16_f32 v218, v84, v85
    v_cvt_pk_bf16_f32 v219, v86, v87
    v_pk_fma_f32 v[60:61], v[160:161], v[114:115], v[60:61] op_sel:[0,0,0] op_sel_hi:[1,0,1] neg_lo:[0,1,0] neg_hi:[0,1,0]
    v_pk_fma_f32 v[62:63], v[162:163], v[114:115], v[62:63] op_sel:[0,0,0] op_sel_hi:[1,0,1] neg_lo:[0,1,0] neg_hi:[0,1,0]
    v_cvt_pk_bf16_f32 v226, v60, v61
    v_cvt_pk_bf16_f32 v227, v62, v63
    v_pk_fma_f32 v[64:65], v[160:161], v[116:117], v[64:65] op_sel:[0,0,0] op_sel_hi:[1,0,1] neg_lo:[0,1,0] neg_hi:[0,1,0]
    v_pk_fma_f32 v[66:67], v[162:163], v[116:117], v[66:67] op_sel:[0,0,0] op_sel_hi:[1,0,1] neg_lo:[0,1,0] neg_hi:[0,1,0]
    v_cvt_pk_bf16_f32 v228, v64, v65
    v_cvt_pk_bf16_f32 v229, v66, v67
    v_mfma_f32_16x16x16_bf16 v[172:175], v[214:215], v[226:227], v[196:199]
    v_mfma_f32_16x16x16_bf16 v[176:179], v[216:217], v[226:227], v[200:203]
    v_mfma_f32_16x16x16_bf16 v[180:183], v[216:217], v[228:229], v[196:199]
    v_mfma_f32_16x16x16_bf16 v[184:187], v[218:219], v[228:229], v[200:203]
    v_pk_fma_f32 v[100:101], v[132:133], v[168:169], v[100:101] op_sel:[0,0,0] op_sel_hi:[1,0,1] neg_lo:[1,0,0] neg_hi:[1,0,0]
    v_pk_fma_f32 v[102:103], v[134:135], v[168:169], v[102:103] op_sel:[0,0,0] op_sel_hi:[1,0,1] neg_lo:[1,0,0] neg_hi:[1,0,0]
    v_pk_mul_f32 v[100:101], v[100:101], v[152:153]
    v_pk_mul_f32 v[102:103], v[102:103], v[154:155]
    v_cvt_pk_bf16_f32 v236, v100, v101
    v_cvt_pk_bf16_f32 v237, v102, v103
    s_load_dword s20, s[18:19], 25344
    v_pk_fma_f32 v[104:105], v[136:137], v[168:169], v[104:105] op_sel:[0,0,0] op_sel_hi:[1,0,1] neg_lo:[1,0,0] neg_hi:[1,0,0]
    v_pk_fma_f32 v[106:107], v[138:139], v[168:169], v[106:107] op_sel:[0,0,0] op_sel_hi:[1,0,1] neg_lo:[1,0,0] neg_hi:[1,0,0]
    v_pk_mul_f32 v[104:105], v[104:105], v[156:157]
    v_pk_mul_f32 v[106:107], v[106:107], v[158:159]
    v_cvt_pk_bf16_f32 v238, v104, v105
    v_cvt_pk_bf16_f32 v239, v106, v107
    v_mul_f32 v192, 0x3eb8aa3b, v115
    v_mul_f32 v193, 0x3eb8aa3b, v117
    v_max_f32 v240, v172, v173
    v_max_f32 v241, v174, v175
    v_max_f32 v242, v176, v177
    v_max_f32 v243, v178, v179
    v_max3_f32 v188, v240, v241, v242
    v_max_f32 v188, v188, v243
    v_mov_b32 v190, v188
    v_max_f32 v244, v180, v181
    s_load_dword s20, s[18:19], 25472
    v_max_f32 v245, v182, v183
    v_max_f32 v246, v184, v185
    v_max_f32 v247, v186, v187
    v_max3_f32 v189, v244, v245, v246
    v_max_f32 v189, v189, v247
    v_mov_b32 v191, v189
    v_permlane16_swap_b32 v188, v190
    s_nop 0
    v_permlane16_swap_b32 v189, v191
    v_max_f32 v188, v188, v190
    v_max_f32 v189, v189, v191
    v_mov_b32 v190, v188
    v_mov_b32 v191, v189
    s_nop 0
    v_permlane32_swap_b32 v188, v190
    v_permlane32_swap_b32 v189, v191
    v_max_f32 v188, v188, v190
    v_max_f32 v189, v189, v191
    s_load_dword s20, s[18:19], 26624
    v_mul_f32 v188, v188, v192
    v_mul_f32 v189, v189, v193
    v_fma_f32 v240, v240, v192, -v188
    v_fma_f32 v241, v241, v192, -v188
    v_fma_f32 v242, v242, v192, -v188
    v_fma_f32 v243, v243, v192, -v188
    v_fma_f32 v244, v244, v193, -v189
    v_fma_f32 v245, v245, v193, -v189
    v_fma_f32 v246, v246, v193, -v189
    v_fma_f32 v247, v247, v193, -v189
    v_exp_f32 v240, v240
    v_exp_f32 v241, v241
    v_exp_f32 v242, v242
    v_exp_f32 v243, v243
    v_exp_f32 v244, v244
    v_exp_f32 v245, v245
    s_load_dword s20, s[18:19], 26752
    v_exp_f32 v246, v246
    v_exp_f32 v247, v247
    v_cvt_pk_bf16_f32 v188, v240, v241
    v_cvt_pk_bf16_f32 v190, v242, v243
    v_cvt_pk_bf16_f32 v189, v244, v245
    v_cvt_pk_bf16_f32 v191, v246, v247
    v_perm_b32 v172, v188, v188, v208
    v_perm_b32 v173, v188, v188, v209
    v_perm_b32 v174, v190, v190, v208
    v_perm_b32 v175, v190, v190, v209
    v_perm_b32 v176, v189, v189, v208
    v_perm_b32 v177, v189, v189, v209
    v_perm_b32 v178, v191, v191, v208
    v_perm_b32 v179, v191, v191, v209
    v_mfma_f32_16x16x32_bf16 v[240:243], v[28:31], v[172:175], 0
    v_mfma_f32_16x16x32_bf16 v[180:183], v[234:237], v[172:175], 0
    v_mfma_f32_16x16x32_bf16 v[244:247], v[28:31], v[176:179], 0
    v_mfma_f32_16x16x32_bf16 v[184:187], v[236:239], v[176:179], 0
    s_nop 4
    v_rcp_f32 v240, v240
    s_nop 0
    v_rcp_f32 v244, v244
    s_load_dword s20, s[18:19], 26880
    v_pk_mul_f32 v[180:181], v[180:181], v[240:241] op_sel:[0,0] op_sel_hi:[1,0]
    v_pk_mul_f32 v[182:183], v[182:183], v[240:241] op_sel:[0,0] op_sel_hi:[1,0]
    v_cvt_pk_bf16_f32 v252, v180, v181
    v_cvt_pk_bf16_f32 v253, v182, v183
    v_pk_mul_f32 v[184:185], v[184:185], v[244:245] op_sel:[0,0] op_sel_hi:[1,0]
    v_pk_mul_f32 v[186:187], v[186:187], v[244:245] op_sel:[0,0] op_sel_hi:[1,0]
    v_cvt_pk_bf16_f32 v254, v184, v185
    v_cvt_pk_bf16_f32 v255, v186, v187
    s_nop 0
    v_permlane16_swap_b32 v252, v254
    v_permlane16_swap_b32 v253, v255
    s_add_u32 s72, s73, 32768
    s_waitcnt vmcnt(0)
    s_add_u32 s74, s76, 1
    v_mov_b32 v8, s74
    v_mov_b32 v9, 0
    s_mov_b64 exec, 1
    s_cmp_eq_u32 s75, 1
    s_cbranch_scc1 L_hf3
    buffer_store_dword v8, v9, s[32:35], s61 offen sc1
    s_branch L_he3
L_hf3:
    buffer_store_dword v8, v9, s[32:35], s61 offen
L_he3:
    s_mov_b64 exec, -1
    buffer_store_dwordx4 v[252:255], v43, s[32:35], s72 offen sc1
    s_xor_b32 s71, s64, 1
    s_mul_i32 s71, s71, 6144
    s_add_u32 s71, s71, 65536
    v_add_u32 v12, s71, v4
    s_xor_b32 s71, s64, 2
    s_mul_i32 s71, s71, 6144
    s_add_u32 s71, s71, 67584
    v_add_u32 v13, s71, v4
    s_xor_b32 s71, s64, 3
    s_mul_i32 s71, s71, 6144
    s_add_u32 s71, s71, 69632
    v_add_u32 v14, s71, v4
    s_mul_i32 s71, s64, 6144
    s_add_u32 s71, s71, 65536
    v_add_u32 v26, s71, v4
    s_load_dword s20, s[18:19], 27008
    v_lshlrev_b32 v27, 10, v2
    v_lshl_add_u32 v27, v3, 3, v27
    s_lshl_b32 s73, s69, 16
    s_lshl_b32 s72, s63, 14
    s_add_u32 s73, s73, s72
    s_lshl_b32 s72, s68, 7
    s_add_u32 s73, s73, s72
    s_lshl_b32 s72, s62, 6
    s_add_u32 s73, s73, s72
    s_add_u32 s73, s73, 0
    buffer_load_dwordx2 v[18:19], v27, s[4:7], s73 offen offset:0
    buffer_load_dwordx2 v[20:21], v27, s[4:7], s73 offen offset:32
    s_lshl_b32 s73, s69, 16
    s_lshl_b32 s72, s63, 14
    s_add_u32 s73, s73, s72
    s_lshl_b32 s72, s68, 7
    s_add_u32 s73, s73, s72
    s_lshl_b32 s72, s62, 6
    s_add_u32 s73, s73, s72
    s_add_u32 s73, s73, 32768
    buffer_load_dwordx2 v[22:23], v27, s[4:7], s73 offen offset:0
    buffer_load_dwordx2 v[24:25], v27, s[4:7], s73 offen offset:32
    s_waitcnt vmcnt(4)
    s_add_u32 s74, s76, 2
    v_mov_b32 v8, s74
    v_mov_b32 v9, 0
    s_mov_b64 exec, 1
    s_cmp_eq_u32 s75, 1
    s_cbranch_scc1 L_hf4
    buffer_store_dword v8, v9, s[32:35], s61 offen sc1
    s_branch L_he4
L_hf4:
    buffer_store_dword v8, v9, s[32:35], s61 offen
L_he4:
    s_mov_b64 exec, -1
    s_load_dword s20, s[18:19], 27136
    s_load_dword s20, s[18:19], 27264
    s_load_dword s20, s[18:19], 27392
    s_load_dword s20, s[18:19], 27520
    s_load_dword s20, s[18:19], 28672
    s_load_dword s20, s[18:19], 28800
    s_load_dword s20, s[18:19], 28928
    s_load_dword s20, s[18:19], 29056
    s_mov_b32 s78, 0
    s_add_u32 s74, s76, 1
L_wait5:
    buffer_load_dword v6, v7, s[32:35], s77 offen sc1
    s_waitcnt vmcnt(0)
    v_subrev_u32 v6, s74, v6
    v_cmp_lt_u32 vcc, 15, v6
    s_nop 1
    s_and_b64 vcc, vcc, s[98:99]
    s_cbranch_scc0 L_go5
    s_add_u32 s78, s78, 1
    s_cmp_lt_u32 s78, 0x40000
    s_cbranch_scc1 L_wait5
L_go5:
    s_nop 1
    s_xor_b32 s71, s63, 0
    s_lshl_b32 s72, s69, 2
    s_add_u32 s71, s71, s72
    s_add_u32 s71, s71, 0
    s_mul_i32 s71, s71, 16
    s_lshl_b32 s72, s64, 2
    s_add_u32 s71, s71, s72
    s_lshl_b32 s71, s71, 10
    s_add_u32 s71, s71, 1048576
    buffer_load_dwordx4 v[128:131], v4, s[32:35], s71 offen offset:0
    buffer_load_dwordx4 v[132:135], v4, s[32:35], s71 offen offset:1024
    buffer_load_dwordx4 v[136:139], v4, s[32:35], s71 offen offset:2048
    buffer_load_dwordx4 v[140:143], v4, s[32:35], s71 offen offset:3072
    s_xor_b32 s71, s63, 1
    s_lshl_b32 s72, s69, 2
    s_add_u32 s71, s71, s72
    s_add_u32 s71, s71, 0
    s_mul_i32 s71, s71, 16
    s_lshl_b32 s72, s64, 2
    s_add_u32 s71, s71, s72
    s_lshl_b32 s71, s71, 10
    s_add_u32 s71, s71, 1048576
    buffer_load_dwordx4 v[144:147], v4, s[32:35], s71 offen offset:0
    buffer_load_dwordx4 v[148:151], v4, s[32:35], s71 offen offset:1024
    buffer_load_dwordx4 v[152:155], v4, s[32:35], s71 offen offset:2048
    buffer_load_dwordx4 v[156:159], v4, s[32:35], s71 offen offset:3072
    s_load_dword s20, s[18:19], 29184
    s_load_dword s20, s[18:19], 29312
    s_load_dword s20, s[18:19], 29440
    s_load_dword s20, s[18:19], 29568
    s_load_dword s20, s[18:19], 30720
    s_load_dword s20, s[18:19], 30848
    s_load_dword s20, s[18:19], 30976
    s_load_dword s20, s[18:19], 31104
    s_mov_b32 s78, 0
    s_add_u32 s74, s76, 2
L_wait6:
    buffer_load_dword v6, v7, s[32:35], s77 offen sc1
    s_waitcnt vmcnt(0)
    v_subrev_u32 v6, s74, v6
    v_cmp_lt_u32 vcc, 15, v6
    s_nop 1
    s_and_b64 vcc, vcc, s[98:99]
    s_cbranch_scc0 L_go6
    s_add_u32 s78, s78, 1
    s_cmp_lt_u32 s78, 0x40000
    s_cbranch_scc1 L_wait6
L_go6:
    s_nop 1
    s_xor_b32 s71, s63, 0
    s_lshl_b32 s72, s69, 2
    s_add_u32 s71, s71, s72
    s_add_u32 s71, s71, 2
    s_mul_i32 s71, s71, 16
    s_lshl_b32 s72, s64, 2
    s_add_u32 s71, s71, s72
    s_lshl_b32 s71, s71, 10
    s_add_u32 s71, s71, 1048576
    buffer_load_dwordx4 v[160:163], v4, s[32:35], s71 offen offset:0
    buffer_load_dwordx4 v[164:167], v4, s[32:35], s71 offen offset:1024
    buffer_load_dwordx4 v[168:171], v4, s[32:35], s71 offen offset:2048
    buffer_load_dwordx4 v[172:175], v4, s[32:35], s71 offen offset:3072
    s_xor_b32 s71, s63, 1
    s_lshl_b32 s72, s69, 2
    s_add_u32 s71, s71, s72
    s_add_u32 s71, s71, 2
    s_mul_i32 s71, s71, 16
    s_lshl_b32 s72, s64, 2
    s_add_u32 s71, s71, s72
    s_lshl_b32 s71, s71, 10
    s_add_u32 s71, s71, 1048576
    buffer_load_dwordx4 v[176:179], v4, s[32:35], s71 offen offset:0
    buffer_load_dwordx4 v[180:183], v4, s[32:35], s71 offen offset:1024
    buffer_load_dwordx4 v[184:187], v4, s[32:35], s71 offen offset:2048
    buffer_load_dwordx4 v[188:191], v4, s[32:35], s71 offen offset:3072
    s_lshl_b32 s71, s66, 2
    s_add_u32 s71, s71, s64
    s_lshl_b32 s71, s71, 12
    s_add_u32 s71, s71, 24117248
    buffer_load_dwordx4 v[192:195], v17, s[32:35], s71 offen offset:0
    buffer_load_dwordx4 v[196:199], v17, s[32:35], s71 offen offset:64
    buffer_load_dwordx4 v[200:203], v17, s[32:35], s71 offen offset:128
    v_mfma_f32_16x16x32_bf16 v[32:35], a[192:195], v[128:131], 0
    v_mfma_f32_16x16x32_bf16 v[36:39], a[196:199], v[128:131], 0
    s_add_u32 s74, s80, 8192
    buffer_load_dwordx4 a[32:35], v4, s[32:35], s74 offen offset:0
    v_mfma_f32_16x16x32_bf16 v[40:43], a[200:203], v[128:131], 0
    v_mfma_f32_16x16x32_bf16 v[44:47], a[204:207], v[128:131], 0
    v_mfma_f32_16x16x32_bf16 v[32:35], a[208:211], v[132:135], v[32:35]
    v_mfma_f32_16x16x32_bf16 v[36:39], a[212:215], v[132:135], v[36:39]
    s_add_u32 s74, s80, 8192
    buffer_load_dwordx4 a[36:39], v4, s[32:35], s74 offen offset:1024
    v_mfma_f32_16x16x32_bf16 v[40:43], a[216:219], v[132:135], v[40:43]
    v_mfma_f32_16x16x32_bf16 v[44:47], a[220:223], v[132:135], v[44:47]
    v_mfma_f32_16x16x32_bf16 v[32:35], a[224:227], v[136:139], v[32:35]
    v_mfma_f32_16x16x32_bf16 v[36:39], a[228:231], v[136:139], v[36:39]
    s_add_u32 s74, s80, 8192
    buffer_load_dwordx4 a[40:43], v4, s[32:35], s74 offen offset:2048
    v_mfma_f32_16x16x32_bf16 v[40:43], a[232:235], v[136:139], v[40:43]
    v_mfma_f32_16x16x32_bf16 v[44:47], a[236:239], v[136:139], v[44:47]
    v_mfma_f32_16x16x32_bf16 v[32:35], a[240:243], v[140:143], v[32:35]
    v_mfma_f32_16x16x32_bf16 v[36:39], a[244:247], v[140:143], v[36:39]
    s_add_u32 s74, s80, 8192
    buffer_load_dwordx4 a[44:47], v4, s[32:35], s74 offen offset:3072
    v_mfma_f32_16x16x32_bf16 v[40:43], a[248:251], v[140:143], v[40:43]
    v_mfma_f32_16x16x32_bf16 v[44:47], a[252:255], v[140:143], v[44:47]
    v_mfma_f32_16x16x32_bf16 v[48:51], a[192:195], v[144:147], 0
    v_mfma_f32_16x16x32_bf16 v[52:55], a[196:199], v[144:147], 0
    v_mfma_f32_16x16x32_bf16 v[56:59], a[200:203], v[144:147], 0
    v_mfma_f32_16x16x32_bf16 v[60:63], a[204:207], v[144:147], 0
    v_mfma_f32_16x16x32_bf16 v[48:51], a[208:211], v[148:151], v[48:51]
    v_mfma_f32_16x16x32_bf16 v[52:55], a[212:215], v[148:151], v[52:55]
    v_mfma_f32_16x16x32_bf16 v[56:59], a[216:219], v[148:151], v[56:59]
    v_mfma_f32_16x16x32_bf16 v[60:63], a[220:223], v[148:151], v[60:63]
    ds_write_b128 v12, v[40:43] offset:0
    ds_write_b128 v12, v[44:47] offset:1024
    v_mfma_f32_16x16x32_bf16 v[48:51], a[224:227], v[152:155], v[48:51]
    v_mfma_f32_16x16x32_bf16 v[52:55], a[228:231], v[152:155], v[52:55]
    v_mfma_f32_16x16x32_bf16 v[56:59], a[232:235], v[152:155], v[56:59]
    v_mfma_f32_16x16x32_bf16 v[60:63], a[236:239], v[152:155], v[60:63]
    v_mfma_f32_16x16x32_bf16 v[48:51], a[240:243], v[156:159], v[48:51]
    v_mfma_f32_16x16x32_bf16 v[52:55], a[244:247], v[156:159], v[52:55]
    v_mfma_f32_16x16x32_bf16 v[56:59], a[248:251], v[156:159], v[56:59]
    v_mfma_f32_16x16x32_bf16 v[60:63], a[252:255], v[156:159], v[60:63]
    s_nop 4
    ds_write_b128 v13, v[48:51] offset:0
    ds_write_b128 v13, v[52:55] offset:1024
    ds_write_b128 v14, v[56:59] offset:0
    ds_write_b128 v14, v[60:63] offset:1024
    s_waitcnt lgkmcnt(0)
    s_barrier
    ds_read_b128 v[96:99], v26 offset:0
    ds_read_b128 v[100:103], v26 offset:1024
    ds_read_b128 v[104:107], v26 offset:2048
    ds_read_b128 v[108:111], v26 offset:3072
    ds_read_b128 v[112:115], v26 offset:4096
    ds_read_b128 v[116:119], v26 offset:5120
    v_lshlrev_b32 v120, 16, v18
    v_and_b32 v121, 0xffff0000, v18
    v_lshlrev_b32 v122, 16, v19
    v_and_b32 v123, 0xffff0000, v19
    v_lshlrev_b32 v124, 16, v20
    v_and_b32 v125, 0xffff0000, v20
    v_lshlrev_b32 v126, 16, v21
    v_and_b32 v127, 0xffff0000, v21
    v_pk_add_f32 v[32:33], v[32:33], v[120:121]
    v_pk_add_f32 v[34:35], v[34:35], v[122:123]
    v_pk_add_f32 v[36:37], v[36:37], v[124:125]
    v_pk_add_f32 v[38:39], v[38:39], v[126:127]
    s_waitcnt lgkmcnt(4)
    v_pk_add_f32 v[32:33], v[32:33], v[96:97]
    v_pk_add_f32 v[34:35], v[34:35], v[98:99]
    v_pk_add_f32 v[36:37], v[36:37], v[100:101]
    v_pk_add_f32 v[38:39], v[38:39], v[102:103]
    s_waitcnt lgkmcnt(2)
    v_pk_add_f32 v[32:33], v[32:33], v[104:105]
    v_pk_add_f32 v[34:35], v[34:35], v[106:107]
    v_pk_add_f32 v[36:37], v[36:37], v[108:109]
    v_pk_add_f32 v[38:39], v[38:39], v[110:111]
    s_waitcnt lgkmcnt(0)
    v_pk_add_f32 v[32:33], v[32:33], v[112:113]
    v_pk_add_f32 v[34:35], v[34:35], v[114:115]
    v_pk_add_f32 v[36:37], v[36:37], v[116:117]
    v_pk_add_f32 v[38:39], v[38:39], v[118:119]
    v_cvt_pk_bf16_f32 v18, v32, v33
    v_cvt_pk_bf16_f32 v19, v34, v35
    v_cvt_pk_bf16_f32 v20, v36, v37
    v_cvt_pk_bf16_f32 v21, v38, v39
    s_lshl_b32 s73, s69, 16
    s_lshl_b32 s72, s63, 14
    s_add_u32 s73, s73, s72
    s_lshl_b32 s72, s68, 11
    s_add_u32 s73, s73, s72
    s_lshl_b32 s72, s62, 10
    s_add_u32 s73, s73, s72
    s_add_u32 s73, s73, 3145728
    v_mfma_f32_16x16x32_bf16 v[40:43], v[18:21], v[18:21], 0
    v_mfma_f32_16x16x32_bf16 v[44:47], v[28:31], v[18:21], 0
    buffer_store_dwordx4 v[18:21], v4, s[32:35], s73 offen sc1
    v_lshlrev_b32 v10, 3, v2
    s_lshl_b32 s71, s69, 13
    s_lshl_b32 s72, s63, 11
    s_add_u32 s71, s71, s72
    s_lshl_b32 s72, s68, 8
    s_add_u32 s71, s71, s72
    s_lshl_b32 s72, s62, 7
    s_add_u32 s71, s71, s72
    s_add_u32 s71, s71, 12582912
    v_cndmask_b32 v45, v40, v41, s[84:85]
    v_cndmask_b32 v45, v45, v42, s[86:87]
    v_cndmask_b32 v45, v45, v43, s[88:89]
    s_mov_b64 exec, s[90:91]
    buffer_store_dwordx2 v[44:45], v10, s[32:35], s71 offen sc1
    s_mov_b64 exec, -1
    s_waitcnt vmcnt(16)
    v_mfma_f32_16x16x32_bf16 v[64:67], a[192:195], v[160:163], 0
    v_mfma_f32_16x16x32_bf16 v[68:71], a[196:199], v[160:163], 0
    v_mfma_f32_16x16x32_bf16 v[72:75], a[200:203], v[160:163], 0
    v_mfma_f32_16x16x32_bf16 v[76:79], a[204:207], v[160:163], 0
    s_waitcnt vmcnt(15)
    v_mfma_f32_16x16x32_bf16 v[64:67], a[208:211], v[164:167], v[64:67]
    v_mfma_f32_16x16x32_bf16 v[68:71], a[212:215], v[164:167], v[68:71]
    v_mfma_f32_16x16x32_bf16 v[72:75], a[216:219], v[164:167], v[72:75]
    v_mfma_f32_16x16x32_bf16 v[76:79], a[220:223], v[164:167], v[76:79]
    s_waitcnt vmcnt(14)
    v_mfma_f32_16x16x32_bf16 v[64:67], a[224:227], v[168:171], v[64:67]
    v_mfma_f32_16x16x32_bf16 v[68:71], a[228:231], v[168:171], v[68:71]
    v_mfma_f32_16x16x32_bf16 v[72:75], a[232:235], v[168:171], v[72:75]
    v_mfma_f32_16x16x32_bf16 v[76:79], a[236:239], v[168:171], v[76:79]
    s_waitcnt vmcnt(13)
    v_mfma_f32_16x16x32_bf16 v[64:67], a[240:243], v[172:175], v[64:67]
    v_mfma_f32_16x16x32_bf16 v[68:71], a[244:247], v[172:175], v[68:71]
    v_mfma_f32_16x16x32_bf16 v[72:75], a[248:251], v[172:175], v[72:75]
    v_mfma_f32_16x16x32_bf16 v[76:79], a[252:255], v[172:175], v[76:79]
    s_waitcnt vmcnt(12)
    v_mfma_f32_16x16x32_bf16 v[80:83], a[192:195], v[176:179], 0
    v_mfma_f32_16x16x32_bf16 v[84:87], a[196:199], v[176:179], 0
    v_mfma_f32_16x16x32_bf16 v[88:91], a[200:203], v[176:179], 0
    v_mfma_f32_16x16x32_bf16 v[92:95], a[204:207], v[176:179], 0
    s_waitcnt vmcnt(11)
    v_mfma_f32_16x16x32_bf16 v[80:83], a[208:211], v[180:183], v[80:83]
    v_mfma_f32_16x16x32_bf16 v[84:87], a[212:215], v[180:183], v[84:87]
    v_mfma_f32_16x16x32_bf16 v[88:91], a[216:219], v[180:183], v[88:91]
    v_mfma_f32_16x16x32_bf16 v[92:95], a[220:223], v[180:183], v[92:95]
    ds_write_b128 v12, v[72:75] offset:24576
    ds_write_b128 v12, v[76:79] offset:25600
    s_waitcnt vmcnt(10)
    v_mfma_f32_16x16x32_bf16 v[80:83], a[224:227], v[184:187], v[80:83]
    v_mfma_f32_16x16x32_bf16 v[84:87], a[228:231], v[184:187], v[84:87]
    v_mfma_f32_16x16x32_bf16 v[88:91], a[232:235], v[184:187], v[88:91]
    v_mfma_f32_16x16x32_bf16 v[92:95], a[236:239], v[184:187], v[92:95]
    s_waitcnt vmcnt(9)
    v_mfma_f32_16x16x32_bf16 v[80:83], a[240:243], v[188:191], v[80:83]
    v_mfma_f32_16x16x32_bf16 v[84:87], a[244:247], v[188:191], v[84:87]
    v_mfma_f32_16x16x32_bf16 v[88:91], a[248:251], v[188:191], v[88:91]
    v_mfma_f32_16x16x32_bf16 v[92:95], a[252:255], v[188:191], v[92:95]
    s_nop 4
    ds_write_b128 v13, v[80:83] offset:24576
    ds_write_b128 v13, v[84:87] offset:25600
    ds_write_b128 v14, v[88:91] offset:24576
    ds_write_b128 v14, v[92:95] offset:25600
    s_waitcnt vmcnt(0)
    s_add_u32 s74, s76, 3
    v_mov_b32 v8, s74
    v_mov_b32 v9, 0
    s_mov_b64 exec, 1
    s_cmp_eq_u32 s75, 1
    s_cbranch_scc1 L_hf7
    buffer_store_dword v8, v9, s[32:35], s61 offen sc1
    s_branch L_he7
L_hf7:
    buffer_store_dword v8, v9, s[32:35], s61 offen
L_he7:
    s_mov_b64 exec, -1
    s_waitcnt lgkmcnt(0)
    s_barrier
    ds_read_b128 v[96:99], v26 offset:24576
    ds_read_b128 v[100:103], v26 offset:25600
    ds_read_b128 v[104:107], v26 offset:26624
    ds_read_b128 v[108:111], v26 offset:27648
    ds_read_b128 v[112:115], v26 offset:28672
    ds_read_b128 v[116:119], v26 offset:29696
    v_lshlrev_b32 v120, 16, v22
    v_and_b32 v121, 0xffff0000, v22
    v_lshlrev_b32 v122, 16, v23
    v_and_b32 v123, 0xffff0000, v23
    v_lshlrev_b32 v124, 16, v24
    v_and_b32 v125, 0xffff0000, v24
    v_lshlrev_b32 v126, 16, v25
    v_and_b32 v127, 0xffff0000, v25
    v_pk_add_f32 v[64:65], v[64:65], v[120:121]
    v_pk_add_f32 v[66:67], v[66:67], v[122:123]
    v_pk_add_f32 v[68:69], v[68:69], v[124:125]
    v_pk_add_f32 v[70:71], v[70:71], v[126:127]
    s_waitcnt lgkmcnt(4)
    v_pk_add_f32 v[64:65], v[64:65], v[96:97]
    v_pk_add_f32 v[66:67], v[66:67], v[98:99]
    v_pk_add_f32 v[68:69], v[68:69], v[100:101]
    v_pk_add_f32 v[70:71], v[70:71], v[102:103]
    s_waitcnt lgkmcnt(2)
    v_pk_add_f32 v[64:65], v[64:65], v[104:105]
    v_pk_add_f32 v[66:67], v[66:67], v[106:107]
    v_pk_add_f32 v[68:69], v[68:69], v[108:109]
    v_pk_add_f32 v[70:71], v[70:71], v[110:111]
    s_waitcnt lgkmcnt(0)
    v_pk_add_f32 v[64:65], v[64:65], v[112:113]
    v_pk_add_f32 v[66:67], v[66:67], v[114:115]
    v_pk_add_f32 v[68:69], v[68:69], v[116:117]
    v_pk_add_f32 v[70:71], v[70:71], v[118:119]
    v_cvt_pk_bf16_f32 v22, v64, v65
    v_cvt_pk_bf16_f32 v23, v66, v67
    v_cvt_pk_bf16_f32 v24, v68, v69
    v_cvt_pk_bf16_f32 v25, v70, v71
    s_lshl_b32 s73, s69, 16
    s_lshl_b32 s72, s63, 14
    s_add_u32 s73, s73, s72
    s_lshl_b32 s72, s68, 11
    s_add_u32 s73, s73, s72
    s_lshl_b32 s72, s62, 10
    s_add_u32 s73, s73, s72
    s_add_u32 s73, s73, 3178496
    v_mfma_f32_16x16x32_bf16 v[72:75], v[22:25], v[22:25], 0
    v_mfma_f32_16x16x32_bf16 v[76:79], v[28:31], v[22:25], 0
    buffer_store_dwordx4 v[22:25], v4, s[32:35], s73 offen sc1
    v_lshlrev_b32 v10, 3, v2
    s_lshl_b32 s71, s69, 13
    s_lshl_b32 s72, s63, 11
    s_add_u32 s71, s71, s72
    s_lshl_b32 s72, s68, 8
    s_add_u32 s71, s71, s72
    s_lshl_b32 s72, s62, 7
    s_add_u32 s71, s71, s72
    s_add_u32 s71, s71, 12587008
    v_cndmask_b32 v77, v72, v73, s[84:85]
    v_cndmask_b32 v77, v77, v74, s[86:87]
    v_cndmask_b32 v77, v77, v75, s[88:89]
    s_mov_b64 exec, s[90:91]
    buffer_store_dwordx2 v[76:77], v10, s[32:35], s71 offen sc1
    s_mov_b64 exec, -1
    v_lshrrev_b32 v8, 1, v3
    v_mul_u32_u24 v8, 196608, v8
    v_lshl_add_u32 v8, v2, 4, v8
    v_and_b32 v9, 1, v3
    s_lshl_b32 s71, s63, 10
    s_lshl_b32 s72, s62, 9
    s_add_u32 s71, s71, s72
    v_lshl_add_u32 v12, v9, 8, v8
    v_add_u32 v12, s71, v12
    s_lshl_b32 s71, s64, 8
    s_add_u32 s71, s71, 2048
    v_mul_u32_u24 v9, 49152, v9
    v_add_u32 v13, v9, v8
    v_add_u32 v13, s71, v13
    v_lshlrev_b32 v26, 3, v2
    v_lshl_add_u32 v26, v3, 9, v26
    v_add_u32 v26, 131072, v26
    s_load_dword s20, s[18:19], 31232
    s_load_dword s20, s[18:19], 31360
    s_load_dword s20, s[18:19], 31488
    s_load_dword s20, s[18:19], 31616
    s_load_dword s20, s[18:19], 32768
    s_load_dword s20, s[18:19], 32896
    s_load_dword s20, s[18:19], 33024
    s_load_dword s20, s[18:19], 33152
    s_load_dword s20, s[18:19], 33280
    s_load_dword s20, s[18:19], 33408
    s_load_dword s20, s[18:19], 33536
    s_load_dword s20, s[18:19], 33664
    s_load_dword s20, s[18:19], 34816
    s_load_dword s20, s[18:19], 34944
    s_mov_b32 s78, 0
    s_add_u32 s74, s76, 3
L_wait8:
    buffer_load_dword v6, v7, s[32:35], s77 offen sc1
    s_waitcnt vmcnt(0)
    v_subrev_u32 v6, s74, v6
    v_cmp_lt_u32 vcc, 15, v6
    s_nop 1
    s_and_b64 vcc, vcc, -1
    s_cbranch_scc0 L_go8
    s_add_u32 s78, s78, 1
    s_cmp_lt_u32 s78, 0x40000
    s_cbranch_scc1 L_wait8
L_go8:
    s_nop 1
    s_add_u32 s74, s76, 4
    v_mov_b32 v8, s74
    v_mov_b32 v9, 0
    s_mov_b64 exec, 1
    s_cmp_eq_u32 s75, 1
    s_cbranch_scc1 L_hf9
    buffer_store_dword v8, v9, s[32:35], s61 offen sc1
    s_branch L_he9
L_hf9:
    buffer_store_dword v8, v9, s[32:35], s61 offen
L_he9:
    s_mov_b64 exec, -1
    s_lshl_b32 s73, s65, 17
    s_add_u32 s73, s73, s60
    s_add_u32 s73, s73, 3145728
    s_add_u32 m0, s60, 0
    s_nop 0
    buffer_load_dwordx4 v4, s[32:35], s73 offen offset:0 lds
    buffer_load_dwordx4 v4, s[32:35], s73 offen offset:1024 lds
    buffer_load_dwordx4 v4, s[32:35], s73 offen offset:2048 lds
    buffer_load_dwordx4 v4, s[32:35], s73 offen offset:3072 lds
    s_lshl_b32 s73, s65, 17
    s_add_u32 s73, s73, s60
    s_add_u32 s73, s73, 3211264
    s_add_u32 m0, s60, 16384
    s_nop 0
    buffer_load_dwordx4 v4, s[32:35], s73 offen offset:0 lds
    buffer_load_dwordx4 v4, s[32:35], s73 offen offset:1024 lds
    buffer_load_dwordx4 v4, s[32:35], s73 offen offset:2048 lds
    buffer_load_dwordx4 v4, s[32:35], s73 offen offset:3072 lds
    s_lshl_b32 s73, s65, 17
    s_add_u32 s73, s73, s60
    s_add_u32 s73, s73, 3162112
    s_add_u32 m0, s60, 32768
    s_nop 0
    buffer_load_dwordx4 v4, s[32:35], s73 offen offset:0 lds
    buffer_load_dwordx4 v4, s[32:35], s73 offen offset:1024 lds
    buffer_load_dwordx4 v4, s[32:35], s73 offen offset:2048 lds
    buffer_load_dwordx4 v4, s[32:35], s73 offen offset:3072 lds
    s_lshl_b32 s73, s65, 17
    s_add_u32 s73, s73, s60
    s_add_u32 s73, s73, 3227648
    s_add_u32 m0, s60, 49152
    s_nop 0
    buffer_load_dwordx4 v4, s[32:35], s73 offen offset:0 lds
    buffer_load_dwordx4 v4, s[32:35], s73 offen offset:1024 lds
    buffer_load_dwordx4 v4, s[32:35], s73 offen offset:2048 lds
    buffer_load_dwordx4 v4, s[32:35], s73 offen offset:3072 lds
    s_lshl_b32 s71, s65, 14
    s_lshl_b32 s72, s63, 11
    s_add_u32 s71, s71, s72
    s_lshl_b32 s72, s62, 13
    s_add_u32 s71, s71, s72
    s_add_u32 s71, s71, 12582912
    s_lshl_b32 s72, s64, 11
    s_add_u32 m0, s72, 131072
    s_nop 0
    buffer_load_dwordx4 v4, s[32:35], s71 offen lds
    buffer_load_dwordx4 v4, s[32:35], s71 offen offset:1024 lds
    v_add_f32_dpp v192, v192, v192 quad_perm:[1,0,3,2] row_mask:0xf bank_mask:0xf
    v_add_f32_dpp v193, v193, v193 quad_perm:[1,0,3,2] row_mask:0xf bank_mask:0xf
    v_add_f32_dpp v194, v194, v194 quad_perm:[1,0,3,2] row_mask:0xf bank_mask:0xf
    v_add_f32_dpp v195, v195, v195 quad_perm:[1,0,3,2] row_mask:0xf bank_mask:0xf
    v_add_f32_dpp v196, v196, v196 quad_perm:[1,0,3,2] row_mask:0xf bank_mask:0xf
    v_add_f32_dpp v197, v197, v197 quad_perm:[1,0,3,2] row_mask:0xf bank_mask:0xf
    v_add_f32_dpp v198, v198, v198 quad_perm:[1,0,3,2] row_mask:0xf bank_mask:0xf
    v_add_f32_dpp v199, v199, v199 quad_perm:[1,0,3,2] row_mask:0xf bank_mask:0xf
    v_add_f32_dpp v200, v200, v200 quad_perm:[1,0,3,2] row_mask:0xf bank_mask:0xf
    v_add_f32_dpp v201, v201, v201 quad_perm:[1,0,3,2] row_mask:0xf bank_mask:0xf
    v_add_f32_dpp v202, v202, v202 quad_perm:[1,0,3,2] row_mask:0xf bank_mask:0xf
    v_add_f32_dpp v203, v203, v203 quad_perm:[1,0,3,2] row_mask:0xf bank_mask:0xf
    v_add_f32_dpp v192, v192, v192 quad_perm:[2,3,0,1] row_mask:0xf bank_mask:0xf
    v_add_f32_dpp v193, v193, v193 quad_perm:[2,3,0,1] row_mask:0xf bank_mask:0xf
    v_add_f32_dpp v194, v194, v194 quad_perm:[2,3,0,1] row_mask:0xf bank_mask:0xf
    v_add_f32_dpp v195, v195, v195 quad_perm:[2,3,0,1] row_mask:0xf bank_mask:0xf
    v_add_f32_dpp v196, v196, v196 quad_perm:[2,3,0,1] row_mask:0xf bank_mask:0xf
    v_add_f32_dpp v197, v197, v197 quad_perm:[2,3,0,1] row_mask:0xf bank_mask:0xf
    v_add_f32_dpp v198, v198, v198 quad_perm:[2,3,0,1] row_mask:0xf bank_mask:0xf
    v_add_f32_dpp v199, v199, v199 quad_perm:[2,3,0,1] row_mask:0xf bank_mask:0xf
    v_add_f32_dpp v200, v200, v200 quad_perm:[2,3,0,1] row_mask:0xf bank_mask:0xf
    v_add_f32_dpp v201, v201, v201 quad_perm:[2,3,0,1] row_mask:0xf bank_mask:0xf
    v_add_f32_dpp v202, v202, v202 quad_perm:[2,3,0,1] row_mask:0xf bank_mask:0xf
    v_add_f32_dpp v203, v203, v203 quad_perm:[2,3,0,1] row_mask:0xf bank_mask:0xf
    v_add_f32_dpp v192, v192, v192 row_half_mirror row_mask:0xf bank_mask:0xf
    v_add_f32_dpp v193, v193, v193 row_half_mirror row_mask:0xf bank_mask:0xf
    v_add_f32_dpp v194, v194, v194 row_half_mirror row_mask:0xf bank_mask:0xf
    v_add_f32_dpp v195, v195, v195 row_half_mirror row_mask:0xf bank_mask:0xf
    v_add_f32_dpp v196, v196, v196 row_half_mirror row_mask:0xf bank_mask:0xf
    v_add_f32_dpp v197, v197, v197 row_half_mirror row_mask:0xf bank_mask:0xf
    v_add_f32_dpp v198, v198, v198 row_half_mirror row_mask:0xf bank_mask:0xf
    v_add_f32_dpp v199, v199, v199 row_half_mirror row_mask:0xf bank_mask:0xf
    v_add_f32_dpp v200, v200, v200 row_half_mirror row_mask:0xf bank_mask:0xf
    v_add_f32_dpp v201, v201, v201 row_half_mirror row_mask:0xf bank_mask:0xf
    v_add_f32_dpp v202, v202, v202 row_half_mirror row_mask:0xf bank_mask:0xf
    v_add_f32_dpp v203, v203, v203 row_half_mirror row_mask:0xf bank_mask:0xf
    v_add_f32_dpp v192, v192, v192 row_mirror row_mask:0xf bank_mask:0xf
    v_add_f32_dpp v193, v193, v193 row_mirror row_mask:0xf bank_mask:0xf
    v_add_f32_dpp v194, v194, v194 row_mirror row_mask:0xf bank_mask:0xf
    v_add_f32_dpp v195, v195, v195 row_mirror row_mask:0xf bank_mask:0xf
    v_add_f32_dpp v196, v196, v196 row_mirror row_mask:0xf bank_mask:0xf
    v_add_f32_dpp v197, v197, v197 row_mirror row_mask:0xf bank_mask:0xf
    v_add_f32_dpp v198, v198, v198 row_mirror row_mask:0xf bank_mask:0xf
    v_add_f32_dpp v199, v199, v199 row_mirror row_mask:0xf bank_mask:0xf
    v_add_f32_dpp v200, v200, v200 row_mirror row_mask:0xf bank_mask:0xf
    v_add_f32_dpp v201, v201, v201 row_mirror row_mask:0xf bank_mask:0xf
    v_add_f32_dpp v202, v202, v202 row_mirror row_mask:0xf bank_mask:0xf
    v_add_f32_dpp v203, v203, v203 row_mirror row_mask:0xf bank_mask:0xf
    s_add_u32 s74, s80, 12288
    buffer_load_dwordx4 a[48:51], v4, s[32:35], s74 offen offset:0
    s_add_u32 s74, s80, 12288
    buffer_load_dwordx4 a[52:55], v4, s[32:35], s74 offen offset:1024
    s_add_u32 s74, s80, 12288
    buffer_load_dwordx4 a[56:59], v4, s[32:35], s74 offen offset:2048
    s_add_u32 s74, s80, 12288
    buffer_load_dwordx4 a[60:63], v4, s[32:35], s74 offen offset:3072
    s_add_u32 s74, s80, 16384
    buffer_load_dwordx4 a[64:67], v4, s[32:35], s74 offen offset:0
    s_add_u32 s74, s80, 16384
    buffer_load_dwordx4 a[68:71], v4, s[32:35], s74 offen offset:1024
    s_add_u32 s74, s80, 16384
    buffer_load_dwordx4 a[72:75], v4, s[32:35], s74 offen offset:2048
    s_add_u32 s74, s80, 16384
    buffer_load_dwordx4 a[76:79], v4, s[32:35], s74 offen offset:3072
    s_load_dword s20, s[18:19], 35072
    s_load_dword s20, s[18:19], 35200
    s_load_dword s20, s[18:19], 35328
    s_load_dword s20, s[18:19], 35456
    s_load_dword s20, s[18:19], 35584
    s_load_dword s20, s[18:19], 35712
    s_load_dword s20, s[18:19], 36864
    s_load_dword s20, s[18:19], 36992
    s_load_dword s20, s[18:19], 37120
    s_load_dword s20, s[18:19], 37248
    s_load_dword s20, s[18:19], 37376
    s_load_dword s20, s[18:19], 37504
    s_load_dword s20, s[18:19], 37632
    s_load_dword s20, s[18:19], 37760
    s_waitcnt vmcnt(8)
    s_waitcnt lgkmcnt(0)
    s_barrier
    s_add_u32 s74, s80, 20480
    buffer_load_dwordx4 a[80:83], v4, s[32:35], s74 offen offset:0
    s_add_u32 s74, s80, 20480
    buffer_load_dwordx4 a[84:87], v4, s[32:35], s74 offen offset:1024
    s_add_u32 s74, s80, 20480
    buffer_load_dwordx4 a[88:91], v4, s[32:35], s74 offen offset:2048
    s_add_u32 s74, s80, 20480
    buffer_load_dwordx4 a[92:95], v4, s[32:35], s74 offen offset:3072
    s_add_u32 s74, s80, 24576
    buffer_load_dwordx4 a[96:99], v4, s[32:35], s74 offen offset:0
    s_add_u32 s74, s80, 24576
    buffer_load_dwordx4 a[100:103], v4, s[32:35], s74 offen offset:1024
    s_add_u32 s74, s80, 24576
    buffer_load_dwordx4 a[104:107], v4, s[32:35], s74 offen offset:2048
    s_add_u32 s74, s80, 24576
    buffer_load_dwordx4 a[108:111], v4, s[32:35], s74 offen offset:3072
    v_add_u32 v14, 0, v4
    ds_read_b128 v[128:131], v14 offset:0
    ds_read_b128 v[132:135], v14 offset:16384
    ds_read_b128 v[136:139], v14 offset:32768
    ds_read_b128 v[140:143], v14 offset:49152
    s_waitcnt lgkmcnt(0)
    v_mfma_f32_16x16x32_bf16 v[32:35], a[0:3], v[128:131], 0
    ds_read_b128 v[144:147], v14 offset:1024
    v_mfma_f32_16x16x32_bf16 v[36:39], a[4:7], v[128:131], 0
    s_add_u32 s74, s80, 28672
    buffer_load_dwordx4 a[112:115], v4, s[32:35], s74 offen offset:0
    v_mfma_f32_16x16x32_bf16 v[40:43], a[8:11], v[128:131], 0
    v_mfma_f32_16x16x32_bf16 v[44:47], a[0:3], v[132:135], 0
    ds_read_b128 v[148:151], v14 offset:17408
    v_mfma_f32_16x16x32_bf16 v[48:51], a[4:7], v[132:135], 0
    v_mfma_f32_16x16x32_bf16 v[52:55], a[8:11], v[132:135], 0
    s_add_u32 s74, s80, 28672
    buffer_load_dwordx4 a[116:119], v4, s[32:35], s74 offen offset:1024
    v_mfma_f32_16x16x32_bf16 v[56:59], a[0:3], v[136:139], 0
    ds_read_b128 v[152:155], v14 offset:33792
    v_mfma_f32_16x16x32_bf16 v[60:63], a[4:7], v[136:139], 0
    ds_read2_b64 v[160:163], v26 offset0:0 offset1:16
    ds_read2_b64 v[164:167], v26 offset0:32 offset1:48
    v_mfma_f32_16x16x32_bf16 v[64:67], a[8:11], v[136:139], 0
    v_add_u32 v26, 2048, v26
    ds_read2_b64 v[168:171], v26 offset0:0 offset1:16
    v_mfma_f32_16x16x32_bf16 v[68:71], a[0:3], v[140:143], 0
    ds_read_b128 v[156:159], v14 offset:50176
    s_add_u32 s74, s80, 28672
    buffer_load_dwordx4 a[120:123], v4, s[32:35], s74 offen offset:2048
    v_mfma_f32_16x16x32_bf16 v[72:75], a[4:7], v[140:143], 0
    ds_read2_b64 v[172:175], v26 offset0:32 offset1:48
    v_add_u32 v26, 2048, v26
    v_mfma_f32_16x16x32_bf16 v[76:79], a[8:11], v[140:143], 0
    ds_read2_b64 v[176:179], v26 offset0:0 offset1:16
    ds_read2_b64 v[180:183], v26 offset0:32 offset1:48
    s_waitcnt lgkmcnt(3)
    v_mfma_f32_16x16x32_bf16 v[32:35], a[12:15], v[144:147], v[32:35]
    ds_read_b128 v[128:131], v14 offset:2048
    v_mfma_f32_16x16x32_bf16 v[36:39], a[16:19], v[144:147], v[36:39]
    v_add_u32 v26, 2048, v26
    ds_read2_b64 v[184:187], v26 offset0:0 offset1:16
    s_add_u32 s74, s80, 28672
    buffer_load_dwordx4 a[124:127], v4, s[32:35], s74 offen offset:3072
    v_mfma_f32_16x16x32_bf16 v[40:43], a[20:23], v[144:147], v[40:43]
    ds_read2_b64 v[188:191], v26 offset0:32 offset1:48
    v_add_u32 v26, 2048, v26
    v_mfma_f32_16x16x32_bf16 v[44:47], a[12:15], v[148:151], v[44:47]
    ds_read_b128 v[132:135], v14 offset:18432
    v_mfma_f32_16x16x32_bf16 v[48:51], a[16:19], v[148:151], v[48:51]
    v_mfma_f32_16x16x32_bf16 v[52:55], a[20:23], v[148:151], v[52:55]
    s_add_u32 s74, s80, 32768
    buffer_load_dwordx4 a[128:131], v4, s[32:35], s74 offen offset:0
    v_mfma_f32_16x16x32_bf16 v[56:59], a[12:15], v[152:155], v[56:59]
    ds_read_b128 v[136:139], v14 offset:34816
    v_mfma_f32_16x16x32_bf16 v[60:63], a[16:19], v[152:155], v[60:63]
    v_mfma_f32_16x16x32_bf16 v[64:67], a[20:23], v[152:155], v[64:67]
    s_waitcnt lgkmcnt(2)
    v_add_f32 v160, v160, v162
    v_mfma_f32_16x16x32_bf16 v[68:71], a[12:15], v[156:159], v[68:71]
    ds_read_b128 v[140:143], v14 offset:51200
    s_add_u32 s74, s80, 32768
    buffer_load_dwordx4 a[132:135], v4, s[32:35], s74 offen offset:1024
    v_mfma_f32_16x16x32_bf16 v[72:75], a[16:19], v[156:159], v[72:75]
    v_add_f32 v161, v161, v163
    v_add_f32 v164, v164, v166
    v_mfma_f32_16x16x32_bf16 v[76:79], a[20:23], v[156:159], v[76:79]
    v_add_f32 v165, v165, v167
    v_add_f32 v168, v168, v170
    s_waitcnt lgkmcnt(0)
    v_mfma_f32_16x16x32_bf16 v[32:35], a[24:27], v[128:131], v[32:35]
    ds_read_b128 v[144:147], v14 offset:3072
    v_mfma_f32_16x16x32_bf16 v[36:39], a[28:31], v[128:131], v[36:39]
    v_add_f32 v169, v169, v171
    v_add_f32 v172, v172, v174
    s_add_u32 s74, s80, 32768
    buffer_load_dwordx4 a[136:139], v4, s[32:35], s74 offen offset:2048
    v_mfma_f32_16x16x32_bf16 v[40:43], a[32:35], v[128:131], v[40:43]
    v_add_f32 v173, v173, v175
    v_add_f32 v176, v176, v178
    v_mfma_f32_16x16x32_bf16 v[44:47], a[24:27], v[132:135], v[44:47]
    ds_read_b128 v[148:151], v14 offset:19456
    v_mfma_f32_16x16x32_bf16 v[48:51], a[28:31], v[132:135], v[48:51]
    v_add_f32 v177, v177, v179
    v_add_f32 v180, v180, v182
    v_mfma_f32_16x16x32_bf16 v[52:55], a[32:35], v[132:135], v[52:55]
    v_add_f32 v181, v181, v183
    v_add_f32 v184, v184, v186
    s_add_u32 s74, s80, 32768
    buffer_load_dwordx4 a[140:143], v4, s[32:35], s74 offen offset:3072
    v_mfma_f32_16x16x32_bf16 v[56:59], a[24:27], v[136:139], v[56:59]
    ds_read_b128 v[152:155], v14 offset:35840
    v_mfma_f32_16x16x32_bf16 v[60:63], a[28:31], v[136:139], v[60:63]
    v_add_f32 v185, v185, v187
    v_add_f32 v188, v188, v190
    v_mfma_f32_16x16x32_bf16 v[64:67], a[32:35], v[136:139], v[64:67]
    v_add_f32 v189, v189, v191
    v_add_f32 v160, v160, v164
    v_mfma_f32_16x16x32_bf16 v[68:71], a[24:27], v[140:143], v[68:71]
    ds_read_b128 v[156:159], v14 offset:52224
    s_add_u32 s74, s80, 36864
    buffer_load_dwordx4 a[144:147], v4, s[32:35], s74 offen offset:0
    v_mfma_f32_16x16x32_bf16 v[72:75], a[28:31], v[140:143], v[72:75]
    v_add_f32 v161, v161, v165
    v_add_f32 v168, v168, v172
    v_mfma_f32_16x16x32_bf16 v[76:79], a[32:35], v[140:143], v[76:79]
    v_add_f32 v169, v169, v173
    v_add_f32 v176, v176, v180
    s_nop 9
    s_mov_b32 s78, 0
    s_add_u32 s74, s76, 4
L_wait10:
    buffer_load_dword v6, v7, s[32:35], s77 offen sc1
    s_waitcnt vmcnt(0)
    v_subrev_u32 v6, s74, v6
    v_cmp_lt_u32 vcc, 15, v6
    s_nop 1
    s_and_b64 vcc, vcc, -1
    s_cbranch_scc0 L_go10
    s_add_u32 s78, s78, 1
    s_cmp_lt_u32 s78, 0x40000
    s_cbranch_scc1 L_wait10
L_go10:
    s_nop 1
    s_waitcnt lgkmcnt(0)
    v_mfma_f32_16x16x32_bf16 v[32:35], a[36:39], v[144:147], v[32:35]
    ds_read_b128 v[128:131], v14 offset:4096
    v_mfma_f32_16x16x32_bf16 v[36:39], a[40:43], v[144:147], v[36:39]
    v_add_f32 v177, v177, v181
    v_add_f32 v184, v184, v188
    s_lshl_b32 s71, s65, 14
    s_lshl_b32 s72, s63, 11
    s_add_u32 s71, s71, s72
    s_lshl_b32 s72, s62, 13
    s_add_u32 s71, s71, s72
    s_add_u32 s71, s71, 12587008
    s_lshl_b32 s72, s64, 11
    s_add_u32 m0, s72, 139264
    s_nop 0
    buffer_load_dwordx4 v4, s[32:35], s71 offen lds
    buffer_load_dwordx4 v4, s[32:35], s71 offen offset:1024 lds
    v_mfma_f32_16x16x32_bf16 v[40:43], a[44:47], v[144:147], v[40:43]
    v_add_f32 v185, v185, v189
    v_mov_b32 v162, v160
    v_mfma_f32_16x16x32_bf16 v[44:47], a[36:39], v[148:151], v[44:47]
    ds_read_b128 v[132:135], v14 offset:20480
    v_mfma_f32_16x16x32_bf16 v[48:51], a[40:43], v[148:151], v[48:51]
    v_mov_b32 v163, v161
    v_mov_b32 v170, v168
    v_mfma_f32_16x16x32_bf16 v[52:55], a[44:47], v[148:151], v[52:55]
    v_mov_b32 v171, v169
    v_mov_b32 v178, v176
    s_add_u32 s74, s80, 36864
    buffer_load_dwordx4 a[148:151], v4, s[32:35], s74 offen offset:1024
    v_mfma_f32_16x16x32_bf16 v[56:59], a[36:39], v[152:155], v[56:59]
    ds_read_b128 v[136:139], v14 offset:36864
    v_mfma_f32_16x16x32_bf16 v[60:63], a[40:43], v[152:155], v[60:63]
    v_mov_b32 v179, v177
    v_mov_b32 v186, v184
    v_mfma_f32_16x16x32_bf16 v[64:67], a[44:47], v[152:155], v[64:67]
    v_mov_b32 v187, v185
    v_permlane16_swap_b32 v160, v162
    v_mfma_f32_16x16x32_bf16 v[68:71], a[36:39], v[156:159], v[68:71]
    ds_read_b128 v[140:143], v14 offset:53248
    s_add_u32 s74, s80, 36864
    buffer_load_dwordx4 a[152:155], v4, s[32:35], s74 offen offset:2048
    v_mfma_f32_16x16x32_bf16 v[72:75], a[40:43], v[156:159], v[72:75]
    v_permlane16_swap_b32 v161, v163
    v_permlane16_swap_b32 v168, v170
    v_mfma_f32_16x16x32_bf16 v[76:79], a[44:47], v[156:159], v[76:79]
    v_permlane16_swap_b32 v169, v171
    v_permlane16_swap_b32 v176, v178
    s_waitcnt lgkmcnt(0)
    v_mfma_f32_16x16x32_bf16 v[32:35], a[48:51], v[128:131], v[32:35]
    ds_read_b128 v[144:147], v14 offset:5120
    v_mfma_f32_16x16x32_bf16 v[36:39], a[52:55], v[128:131], v[36:39]
    v_permlane16_swap_b32 v177, v179
    v_permlane16_swap_b32 v184, v186
    s_add_u32 s74, s80, 36864
    buffer_load_dwordx4 a[156:159], v4, s[32:35], s74 offen offset:3072
    v_mfma_f32_16x16x32_bf16 v[40:43], a[56:59], v[128:131], v[40:43]
    v_permlane16_swap_b32 v185, v187
    v_add_f32 v160, v160, v162
    v_mfma_f32_16x16x32_bf16 v[44:47], a[48:51], v[132:135], v[44:47]
    ds_read_b128 v[148:151], v14 offset:21504
    v_mfma_f32_16x16x32_bf16 v[48:51], a[52:55], v[132:135], v[48:51]
    v_add_f32 v161, v161, v163
    v_add_f32 v168, v168, v170
    v_mfma_f32_16x16x32_bf16 v[52:55], a[56:59], v[132:135], v[52:55]
    v_add_f32 v169, v169, v171
    v_add_f32 v176, v176, v178
    s_add_u32 s74, s80, 40960
    buffer_load_dwordx4 a[160:163], v4, s[32:35], s74 offen offset:0
    v_mfma_f32_16x16x32_bf16 v[56:59], a[48:51], v[136:139], v[56:59]
    ds_read_b128 v[152:155], v14 offset:37888
    v_mfma_f32_16x16x32_bf16 v[60:63], a[52:55], v[136:139], v[60:63]
    v_add_f32 v177, v177, v179
    v_add_f32 v184, v184, v186
    v_mfma_f32_16x16x32_bf16 v[64:67], a[56:59], v[136:139], v[64:67]
    v_add_f32 v185, v185, v187
    v_mov_b32 v162, v160
    v_mfma_f32_16x16x32_bf16 v[68:71], a[48:51], v[140:143], v[68:71]
    ds_read_b128 v[156:159], v14 offset:54272
    s_add_u32 s74, s80, 40960
    buffer_load_dwordx4 a[164:167], v4, s[32:35], s74 offen offset:1024
    v_mfma_f32_16x16x32_bf16 v[72:75], a[52:55], v[140:143], v[72:75]
    v_mov_b32 v163, v161
    v_mov_b32 v170, v168
    v_mfma_f32_16x16x32_bf16 v[76:79], a[56:59], v[140:143], v[76:79]
    v_mov_b32 v171, v169
    v_mov_b32 v178, v176
    s_waitcnt lgkmcnt(0)
    v_mfma_f32_16x16x32_bf16 v[32:35], a[60:63], v[144:147], v[32:35]
    ds_read_b128 v[128:131], v14 offset:6144
    v_mfma_f32_16x16x32_bf16 v[36:39], a[64:67], v[144:147], v[36:39]
    v_mov_b32 v179, v177
    v_mov_b32 v186, v184
    s_add_u32 s74, s80, 40960
    buffer_load_dwordx4 a[168:171], v4, s[32:35], s74 offen offset:2048
    v_mfma_f32_16x16x32_bf16 v[40:43], a[68:71], v[144:147], v[40:43]
    v_mov_b32 v187, v185
    v_permlane32_swap_b32 v160, v162
    v_mfma_f32_16x16x32_bf16 v[44:47], a[60:63], v[148:151], v[44:47]
    ds_read_b128 v[132:135], v14 offset:22528
    v_mfma_f32_16x16x32_bf16 v[48:51], a[64:67], v[148:151], v[48:51]
    v_permlane32_swap_b32 v161, v163
    v_permlane32_swap_b32 v168, v170
    v_mfma_f32_16x16x32_bf16 v[52:55], a[68:71], v[148:151], v[52:55]
    v_permlane32_swap_b32 v169, v171
    v_permlane32_swap_b32 v176, v178
    s_lshl_b32 s73, s65, 17
    s_add_u32 s73, s73, s60
    s_add_u32 s73, s73, 3178496
    s_add_u32 m0, s60, 65536
    s_nop 0
    buffer_load_dwordx4 v4, s[32:35], s73 offen offset:0 lds
    v_mfma_f32_16x16x32_bf16 v[56:59], a[60:63], v[152:155], v[56:59]
    ds_read_b128 v[136:139], v14 offset:38912
    v_mfma_f32_16x16x32_bf16 v[60:63], a[64:67], v[152:155], v[60:63]
    v_permlane32_swap_b32 v177, v179
    v_permlane32_swap_b32 v184, v186
    v_mfma_f32_16x16x32_bf16 v[64:67], a[68:71], v[152:155], v[64:67]
    v_permlane32_swap_b32 v185, v187
    v_add_f32 v160, v160, v162
    v_mfma_f32_16x16x32_bf16 v[68:71], a[60:63], v[156:159], v[68:71]
    ds_read_b128 v[140:143], v14 offset:55296
    buffer_load_dwordx4 v4, s[32:35], s73 offen offset:1024 lds
    v_mfma_f32_16x16x32_bf16 v[72:75], a[64:67], v[156:159], v[72:75]
    v_add_f32 v161, v161, v163
    v_add_f32 v168, v168, v170
    v_mfma_f32_16x16x32_bf16 v[76:79], a[68:71], v[156:159], v[76:79]
    v_add_f32 v169, v169, v171
    v_add_f32 v176, v176, v178
    s_waitcnt lgkmcnt(0)
    v_mfma_f32_16x16x32_bf16 v[32:35], a[72:75], v[128:131], v[32:35]
    ds_read_b128 v[144:147], v14 offset:7168
    v_mfma_f32_16x16x32_bf16 v[36:39], a[76:79], v[128:131], v[36:39]
    v_add_f32 v177, v177, v179
    v_add_f32 v184, v184, v186
    buffer_load_dwordx4 v4, s[32:35], s73 offen offset:2048 lds
    v_mfma_f32_16x16x32_bf16 v[40:43], a[80:83], v[128:131], v[40:43]
    v_add_f32 v185, v185, v187
    v_mul_f32 v160, 0x3b000000, v160
    v_mfma_f32_16x16x32_bf16 v[44:47], a[72:75], v[132:135], v[44:47]
    ds_read_b128 v[148:151], v14 offset:23552
    v_mfma_f32_16x16x32_bf16 v[48:51], a[76:79], v[132:135], v[48:51]
    v_mul_f32 v168, 0x3b000000, v168
    v_mul_f32 v176, 0x3b000000, v176
    v_mfma_f32_16x16x32_bf16 v[52:55], a[80:83], v[132:135], v[52:55]
    v_mul_f32 v184, 0x3b000000, v184
    v_mul_f32 v161, 0x3b000000, v161
    buffer_load_dwordx4 v4, s[32:35], s73 offen offset:3072 lds
    v_mfma_f32_16x16x32_bf16 v[56:59], a[72:75], v[136:139], v[56:59]
    ds_read_b128 v[152:155], v14 offset:39936
    v_mfma_f32_16x16x32_bf16 v[60:63], a[76:79], v[136:139], v[60:63]
    v_mul_f32 v169, 0x3b000000, v169
    v_mul_f32 v177, 0x3b000000, v177
    v_mfma_f32_16x16x32_bf16 v[64:67], a[80:83], v[136:139], v[64:67]
    v_mul_f32 v185, 0x3b000000, v185
    v_fma_f32 v161, -v160, v160, v161
    v_mfma_f32_16x16x32_bf16 v[68:71], a[72:75], v[140:143], v[68:71]
    ds_read_b128 v[156:159], v14 offset:56320
    s_lshl_b32 s73, s65, 17
    s_add_u32 s73, s73, s60
    s_add_u32 s73, s73, 3244032
    s_add_u32 m0, s60, 81920
    s_nop 0
    buffer_load_dwordx4 v4, s[32:35], s73 offen offset:0 lds
    v_mfma_f32_16x16x32_bf16 v[72:75], a[76:79], v[140:143], v[72:75]
    v_fma_f32 v169, -v168, v168, v169
    v_fma_f32 v177, -v176, v176, v177
    v_mfma_f32_16x16x32_bf16 v[76:79], a[80:83], v[140:143], v[76:79]
    v_fma_f32 v185, -v184, v184, v185
    v_max_f32 v161, 0, v161
    s_waitcnt lgkmcnt(0)
    v_mfma_f32_16x16x32_bf16 v[32:35], a[84:87], v[144:147], v[32:35]
    ds_read_b128 v[128:131], v14 offset:8192
    v_mfma_f32_16x16x32_bf16 v[36:39], a[88:91], v[144:147], v[36:39]
    v_max_f32 v169, 0, v169
    v_max_f32 v177, 0, v177
    buffer_load_dwordx4 v4, s[32:35], s73 offen offset:1024 lds
    v_mfma_f32_16x16x32_bf16 v[40:43], a[92:95], v[144:147], v[40:43]
    v_max_f32 v185, 0, v185
    v_add_f32 v161, 0x3727c5ac, v161
    v_mfma_f32_16x16x32_bf16 v[44:47], a[84:87], v[148:151], v[44:47]
    ds_read_b128 v[132:135], v14 offset:24576
    v_mfma_f32_16x16x32_bf16 v[48:51], a[88:91], v[148:151], v[48:51]
    v_add_f32 v169, 0x3727c5ac, v169
    v_add_f32 v177, 0x3727c5ac, v177
    v_mfma_f32_16x16x32_bf16 v[52:55], a[92:95], v[148:151], v[52:55]
    v_add_f32 v185, 0x3727c5ac, v185
    v_rcp_f32 v161, v161
    buffer_load_dwordx4 v4, s[32:35], s73 offen offset:2048 lds
    v_mfma_f32_16x16x32_bf16 v[56:59], a[84:87], v[152:155], v[56:59]
    ds_read_b128 v[136:139], v14 offset:40960
    v_mfma_f32_16x16x32_bf16 v[60:63], a[88:91], v[152:155], v[60:63]
    v_rcp_f32 v169, v169
    v_rcp_f32 v177, v177
    v_mfma_f32_16x16x32_bf16 v[64:67], a[92:95], v[152:155], v[64:67]
    v_rcp_f32 v185, v185
    v_cmp_gt_u32 vcc, 32, v1
    v_mfma_f32_16x16x32_bf16 v[68:71], a[84:87], v[156:159], v[68:71]
    ds_read_b128 v[140:143], v14 offset:57344
    buffer_load_dwordx4 v4, s[32:35], s73 offen offset:3072 lds
    v_mfma_f32_16x16x32_bf16 v[72:75], a[88:91], v[156:159], v[72:75]
    s_nop 1
    v_cndmask_b32 v162, v169, v161, vcc
    v_mfma_f32_16x16x32_bf16 v[76:79], a[92:95], v[156:159], v[76:79]
    v_cndmask_b32 v178, v185, v177, vcc
    s_waitcnt lgkmcnt(0)
    v_mfma_f32_16x16x32_bf16 v[32:35], a[96:99], v[128:131], v[32:35]
    ds_read_b128 v[144:147], v14 offset:9216
    v_mfma_f32_16x16x32_bf16 v[36:39], a[100:103], v[128:131], v[36:39]
    s_lshl_b32 s73, s65, 17
    s_add_u32 s73, s73, s60
    s_add_u32 s73, s73, 3194880
    s_add_u32 m0, s60, 98304
    s_nop 0
    buffer_load_dwordx4 v4, s[32:35], s73 offen offset:0 lds
    v_mfma_f32_16x16x32_bf16 v[40:43], a[104:107], v[128:131], v[40:43]
    v_mfma_f32_16x16x32_bf16 v[44:47], a[96:99], v[132:135], v[44:47]
    ds_read_b128 v[148:151], v14 offset:25600
    v_mfma_f32_16x16x32_bf16 v[48:51], a[100:103], v[132:135], v[48:51]
    v_mfma_f32_16x16x32_bf16 v[52:55], a[104:107], v[132:135], v[52:55]
    buffer_load_dwordx4 v4, s[32:35], s73 offen offset:1024 lds
    v_mfma_f32_16x16x32_bf16 v[56:59], a[96:99], v[136:139], v[56:59]
    ds_read_b128 v[152:155], v14 offset:41984
    v_mfma_f32_16x16x32_bf16 v[60:63], a[100:103], v[136:139], v[60:63]
    v_mfma_f32_16x16x32_bf16 v[64:67], a[104:107], v[136:139], v[64:67]
    v_mfma_f32_16x16x32_bf16 v[68:71], a[96:99], v[140:143], v[68:71]
    ds_read_b128 v[156:159], v14 offset:58368
    buffer_load_dwordx4 v4, s[32:35], s73 offen offset:2048 lds
    v_mfma_f32_16x16x32_bf16 v[72:75], a[100:103], v[140:143], v[72:75]
    v_mfma_f32_16x16x32_bf16 v[76:79], a[104:107], v[140:143], v[76:79]
    s_waitcnt vmcnt(17)
    s_barrier
    s_waitcnt lgkmcnt(0)
    v_mfma_f32_16x16x32_bf16 v[32:35], a[108:111], v[144:147], v[32:35]
    ds_read_b128 v[128:131], v14 offset:10240
    v_mfma_f32_16x16x32_bf16 v[36:39], a[112:115], v[144:147], v[36:39]
    ds_read2_b64 v[80:83], v26 offset0:0 offset1:16
    ds_read2_b64 v[84:87], v26 offset0:32 offset1:48
    buffer_load_dwordx4 v4, s[32:35], s73 offen offset:3072 lds
    v_mfma_f32_16x16x32_bf16 v[40:43], a[116:119], v[144:147], v[40:43]
    v_add_u32 v26, 2048, v26
    ds_read2_b64 v[88:91], v26 offset0:0 offset1:16
    v_mfma_f32_16x16x32_bf16 v[44:47], a[108:111], v[148:151], v[44:47]
    ds_read_b128 v[132:135], v14 offset:26624
    v_mfma_f32_16x16x32_bf16 v[48:51], a[112:115], v[148:151], v[48:51]
    ds_read2_b64 v[92:95], v26 offset0:32 offset1:48
    v_add_u32 v26, 2048, v26
    v_mfma_f32_16x16x32_bf16 v[52:55], a[116:119], v[148:151], v[52:55]
    ds_read2_b64 v[96:99], v26 offset0:0 offset1:16
    ds_read2_b64 v[100:103], v26 offset0:32 offset1:48
    s_lshl_b32 s73, s65, 17
    s_add_u32 s73, s73, s60
    s_add_u32 s73, s73, 3260416
    s_add_u32 m0, s60, 114688
    s_nop 0
    buffer_load_dwordx4 v4, s[32:35], s73 offen offset:0 lds
    v_mfma_f32_16x16x32_bf16 v[56:59], a[108:111], v[152:155], v[56:59]
    ds_read_b128 v[136:139], v14 offset:43008
    v_mfma_f32_16x16x32_bf16 v[60:63], a[112:115], v[152:155], v[60:63]
    v_add_u32 v26, 2048, v26
    ds_read2_b64 v[104:107], v26 offset0:0 offset1:16
    v_mfma_f32_16x16x32_bf16 v[64:67], a[116:119], v[152:155], v[64:67]
    ds_read2_b64 v[108:111], v26 offset0:32 offset1:48
    v_add_u32 v26, 2048, v26
    v_mfma_f32_16x16x32_bf16 v[68:71], a[108:111], v[156:159], v[68:71]
    ds_read_b128 v[140:143], v14 offset:59392
    buffer_load_dwordx4 v4, s[32:35], s73 offen offset:1024 lds
    v_mfma_f32_16x16x32_bf16 v[72:75], a[112:115], v[156:159], v[72:75]
    v_mfma_f32_16x16x32_bf16 v[76:79], a[116:119], v[156:159], v[76:79]
    s_waitcnt lgkmcnt(0)
    v_mfma_f32_16x16x32_bf16 v[32:35], a[120:123], v[128:131], v[32:35]
    ds_read_b128 v[144:147], v14 offset:11264
    v_mfma_f32_16x16x32_bf16 v[36:39], a[124:127], v[128:131], v[36:39]
    buffer_load_dwordx4 v4, s[32:35], s73 offen offset:2048 lds
    v_mfma_f32_16x16x32_bf16 v[40:43], a[128:131], v[128:131], v[40:43]
    v_add_f32 v80, v80, v82
    v_mfma_f32_16x16x32_bf16 v[44:47], a[120:123], v[132:135], v[44:47]
    ds_read_b128 v[148:151], v14 offset:27648
    v_mfma_f32_16x16x32_bf16 v[48:51], a[124:127], v[132:135], v[48:51]
    v_add_f32 v81, v81, v83
    v_add_f32 v84, v84, v86
    v_mfma_f32_16x16x32_bf16 v[52:55], a[128:131], v[132:135], v[52:55]
    v_add_f32 v85, v85, v87
    v_add_f32 v88, v88, v90
    buffer_load_dwordx4 v4, s[32:35], s73 offen offset:3072 lds
    v_mfma_f32_16x16x32_bf16 v[56:59], a[120:123], v[136:139], v[56:59]
    ds_read_b128 v[152:155], v14 offset:44032
    v_mfma_f32_16x16x32_bf16 v[60:63], a[124:127], v[136:139], v[60:63]
    v_add_f32 v89, v89, v91
    v_add_f32 v92, v92, v94
    v_mfma_f32_16x16x32_bf16 v[64:67], a[128:131], v[136:139], v[64:67]
    v_add_f32 v93, v93, v95
    v_add_f32 v96, v96, v98
    v_mfma_f32_16x16x32_bf16 v[68:71], a[120:123], v[140:143], v[68:71]
    ds_read_b128 v[156:159], v14 offset:60416
    s_add_u32 s74, s80, 40960
    buffer_load_dwordx4 a[172:175], v4, s[32:35], s74 offen offset:3072
    v_mfma_f32_16x16x32_bf16 v[72:75], a[124:127], v[140:143], v[72:75]
    v_add_f32 v97, v97, v99
    v_add_f32 v100, v100, v102
    v_mfma_f32_16x16x32_bf16 v[76:79], a[128:131], v[140:143], v[76:79]
    v_add_f32 v101, v101, v103
    v_add_f32 v104, v104, v106
    s_waitcnt lgkmcnt(0)
    v_mfma_f32_16x16x32_bf16 v[32:35], a[132:135], v[144:147], v[32:35]
    ds_read_b128 v[128:131], v14 offset:12288
    v_mfma_f32_16x16x32_bf16 v[36:39], a[136:139], v[144:147], v[36:39]
    v_add_f32 v105, v105, v107
    v_add_f32 v108, v108, v110
    s_add_u32 s74, s80, 45056
    buffer_load_dwordx4 a[176:179], v4, s[32:35], s74 offen offset:0
    v_mfma_f32_16x16x32_bf16 v[40:43], a[140:143], v[144:147], v[40:43]
    v_add_f32 v109, v109, v111
    v_add_f32 v80, v80, v84
    v_mfma_f32_16x16x32_bf16 v[44:47], a[132:135], v[148:151], v[44:47]
    ds_read_b128 v[132:135], v14 offset:28672
    v_mfma_f32_16x16x32_bf16 v[48:51], a[136:139], v[148:151], v[48:51]
    v_add_f32 v81, v81, v85
    v_add_f32 v88, v88, v92
    v_mfma_f32_16x16x32_bf16 v[52:55], a[140:143], v[148:151], v[52:55]
    v_add_f32 v89, v89, v93
    v_add_f32 v96, v96, v100
    s_add_u32 s74, s80, 45056
    buffer_load_dwordx4 a[180:183], v4, s[32:35], s74 offen offset:1024
    v_mfma_f32_16x16x32_bf16 v[56:59], a[132:135], v[152:155], v[56:59]
    ds_read_b128 v[136:139], v14 offset:45056
    v_mfma_f32_16x16x32_bf16 v[60:63], a[136:139], v[152:155], v[60:63]
    v_add_f32 v97, v97, v101
    v_add_f32 v104, v104, v108
    v_mfma_f32_16x16x32_bf16 v[64:67], a[140:143], v[152:155], v[64:67]
    v_add_f32 v105, v105, v109
    v_mov_b32 v82, v80
    v_mfma_f32_16x16x32_bf16 v[68:71], a[132:135], v[156:159], v[68:71]
    ds_read_b128 v[140:143], v14 offset:61440
    s_add_u32 s74, s80, 45056
    buffer_load_dwordx4 a[184:187], v4, s[32:35], s74 offen offset:2048
    v_mfma_f32_16x16x32_bf16 v[72:75], a[136:139], v[156:159], v[72:75]
    v_mov_b32 v83, v81
    v_mov_b32 v90, v88
    v_mfma_f32_16x16x32_bf16 v[76:79], a[140:143], v[156:159], v[76:79]
    v_mov_b32 v91, v89
    v_mov_b32 v98, v96
    s_waitcnt lgkmcnt(0)
    s_waitcnt vmcnt(24)
    v_mfma_f32_16x16x32_bf16 v[32:35], a[144:147], v[128:131], v[32:35]
    ds_read_b128 v[144:147], v14 offset:13312
    v_mfma_f32_16x16x32_bf16 v[36:39], a[148:151], v[128:131], v[36:39]
    v_mov_b32 v99, v97
    v_mov_b32 v106, v104
    s_add_u32 s74, s80, 45056
    buffer_load_dwordx4 a[188:191], v4, s[32:35], s74 offen offset:3072
    v_mfma_f32_16x16x32_bf16 v[40:43], a[152:155], v[128:131], v[40:43]
    v_mov_b32 v107, v105
    v_permlane16_swap_b32 v80, v82
    v_mfma_f32_16x16x32_bf16 v[44:47], a[144:147], v[132:135], v[44:47]
    ds_read_b128 v[148:151], v14 offset:29696
    v_mfma_f32_16x16x32_bf16 v[48:51], a[148:151], v[132:135], v[48:51]
    v_permlane16_swap_b32 v81, v83
    v_permlane16_swap_b32 v88, v90
    v_mfma_f32_16x16x32_bf16 v[52:55], a[152:155], v[132:135], v[52:55]
    v_permlane16_swap_b32 v89, v91
    v_permlane16_swap_b32 v96, v98
    v_mfma_f32_16x16x32_bf16 v[56:59], a[144:147], v[136:139], v[56:59]
    ds_read_b128 v[152:155], v14 offset:46080
    v_mfma_f32_16x16x32_bf16 v[60:63], a[148:151], v[136:139], v[60:63]
    v_permlane16_swap_b32 v97, v99
    v_permlane16_swap_b32 v104, v106
    v_mfma_f32_16x16x32_bf16 v[64:67], a[152:155], v[136:139], v[64:67]
    v_permlane16_swap_b32 v105, v107
    v_add_f32 v80, v80, v82
    v_mfma_f32_16x16x32_bf16 v[68:71], a[144:147], v[140:143], v[68:71]
    ds_read_b128 v[156:159], v14 offset:62464
    v_mfma_f32_16x16x32_bf16 v[72:75], a[148:151], v[140:143], v[72:75]
    v_add_f32 v81, v81, v83
    v_add_f32 v88, v88, v90
    v_mfma_f32_16x16x32_bf16 v[76:79], a[152:155], v[140:143], v[76:79]
    v_add_f32 v89, v89, v91
    v_add_f32 v96, v96, v98
    s_waitcnt lgkmcnt(0)
    s_waitcnt vmcnt(22)
    v_mfma_f32_16x16x32_bf16 v[32:35], a[156:159], v[144:147], v[32:35]
    ds_read_b128 v[128:131], v14 offset:14336
    v_mfma_f32_16x16x32_bf16 v[36:39], a[160:163], v[144:147], v[36:39]
    v_add_f32 v97, v97, v99
    v_add_f32 v104, v104, v106
    v_mfma_f32_16x16x32_bf16 v[40:43], a[164:167], v[144:147], v[40:43]
    v_add_f32 v105, v105, v107
    v_mov_b32 v82, v80
    v_mfma_f32_16x16x32_bf16 v[44:47], a[156:159], v[148:151], v[44:47]
    ds_read_b128 v[132:135], v14 offset:30720
    v_mfma_f32_16x16x32_bf16 v[48:51], a[160:163], v[148:151], v[48:51]
    v_mov_b32 v83, v81
    v_mov_b32 v90, v88
    v_mfma_f32_16x16x32_bf16 v[52:55], a[164:167], v[148:151], v[52:55]
    v_mov_b32 v91, v89
    v_mov_b32 v98, v96
    v_mfma_f32_16x16x32_bf16 v[56:59], a[156:159], v[152:155], v[56:59]
    ds_read_b128 v[136:139], v14 offset:47104
    v_mfma_f32_16x16x32_bf16 v[60:63], a[160:163], v[152:155], v[60:63]
    v_mov_b32 v99, v97
    v_mov_b32 v106, v104
    v_mfma_f32_16x16x32_bf16 v[64:67], a[164:167], v[152:155], v[64:67]
    v_mov_b32 v107, v105
    v_permlane32_swap_b32 v80, v82
    v_mfma_f32_16x16x32_bf16 v[68:71], a[156:159], v[156:159], v[68:71]
    ds_read_b128 v[140:143], v14 offset:63488
    v_mfma_f32_16x16x32_bf16 v[72:75], a[160:163], v[156:159], v[72:75]
    v_permlane32_swap_b32 v81, v83
    v_permlane32_swap_b32 v88, v90
    v_mfma_f32_16x16x32_bf16 v[76:79], a[164:167], v[156:159], v[76:79]
    v_permlane32_swap_b32 v89, v91
    v_permlane32_swap_b32 v96, v98
    s_waitcnt lgkmcnt(0)
    s_waitcnt vmcnt(3)
    v_mfma_f32_16x16x32_bf16 v[32:35], a[168:171], v[128:131], v[32:35]
    ds_read_b128 v[144:147], v14 offset:15360
    v_mfma_f32_16x16x32_bf16 v[36:39], a[172:175], v[128:131], v[36:39]
    v_permlane32_swap_b32 v97, v99
    v_permlane32_swap_b32 v104, v106
    v_mfma_f32_16x16x32_bf16 v[40:43], a[176:179], v[128:131], v[40:43]
    v_permlane32_swap_b32 v105, v107
    v_add_f32 v80, v80, v82
    v_mfma_f32_16x16x32_bf16 v[44:47], a[168:171], v[132:135], v[44:47]
    ds_read_b128 v[148:151], v14 offset:31744
    v_mfma_f32_16x16x32_bf16 v[48:51], a[172:175], v[132:135], v[48:51]
    v_add_f32 v81, v81, v83
    v_add_f32 v88, v88, v90
    v_mfma_f32_16x16x32_bf16 v[52:55], a[176:179], v[132:135], v[52:55]
    v_add_f32 v89, v89, v91
    v_add_f32 v96, v96, v98
    v_mfma_f32_16x16x32_bf16 v[56:59], a[168:171], v[136:139], v[56:59]
    ds_read_b128 v[152:155], v14 offset:48128
    v_mfma_f32_16x16x32_bf16 v[60:63], a[172:175], v[136:139], v[60:63]
    v_add_f32 v97, v97, v99
    v_add_f32 v104, v104, v106
    v_mfma_f32_16x16x32_bf16 v[64:67], a[176:179], v[136:139], v[64:67]
    v_add_f32 v105, v105, v107
    v_mul_f32 v164, 0x3b000000, v80
    v_mfma_f32_16x16x32_bf16 v[68:71], a[168:171], v[140:143], v[68:71]
    ds_read_b128 v[156:159], v14 offset:64512
    v_mfma_f32_16x16x32_bf16 v[72:75], a[172:175], v[140:143], v[72:75]
    v_mul_f32 v172, 0x3b000000, v88
    v_mul_f32 v180, 0x3b000000, v96
    v_mfma_f32_16x16x32_bf16 v[76:79], a[176:179], v[140:143], v[76:79]
    v_mul_f32 v188, 0x3b000000, v104
    v_mul_f32 v81, 0x3b000000, v81
    s_waitcnt lgkmcnt(0)
    s_waitcnt vmcnt(0)
    v_mfma_f32_16x16x32_bf16 v[32:35], a[180:183], v[144:147], v[32:35]
    v_mul_f32 v89, 0x3b000000, v89
    v_mul_f32 v97, 0x3b000000, v97
    v_mfma_f32_16x16x32_bf16 v[36:39], a[184:187], v[144:147], v[36:39]
    v_mul_f32 v105, 0x3b000000, v105
    v_fma_f32 v81, -v164, v164, v81
    v_mfma_f32_16x16x32_bf16 v[40:43], a[188:191], v[144:147], v[40:43]
    v_fma_f32 v89, -v172, v172, v89
    v_fma_f32 v97, -v180, v180, v97
    v_mfma_f32_16x16x32_bf16 v[44:47], a[180:183], v[148:151], v[44:47]
    v_fma_f32 v105, -v188, v188, v105
    v_max_f32 v81, 0, v81
    v_mfma_f32_16x16x32_bf16 v[48:51], a[184:187], v[148:151], v[48:51]
    v_max_f32 v89, 0, v89
    v_max_f32 v97, 0, v97
    v_mfma_f32_16x16x32_bf16 v[52:55], a[188:191], v[148:151], v[52:55]
    v_max_f32 v105, 0, v105
    v_add_f32 v81, 0x3727c5ac, v81
    v_mfma_f32_16x16x32_bf16 v[56:59], a[180:183], v[152:155], v[56:59]
    v_add_f32 v89, 0x3727c5ac, v89
    v_add_f32 v97, 0x3727c5ac, v97
    v_mfma_f32_16x16x32_bf16 v[60:63], a[184:187], v[152:155], v[60:63]
    v_add_f32 v105, 0x3727c5ac, v105
    v_rcp_f32 v165, v81
    v_mfma_f32_16x16x32_bf16 v[64:67], a[188:191], v[152:155], v[64:67]
    v_rcp_f32 v173, v89
    v_rcp_f32 v181, v97
    v_mfma_f32_16x16x32_bf16 v[68:71], a[180:183], v[156:159], v[68:71]
    v_rcp_f32 v189, v105
    v_cmp_gt_u32 vcc, 32, v1
    v_mfma_f32_16x16x32_bf16 v[72:75], a[184:187], v[156:159], v[72:75]
    s_nop 1
    v_cndmask_b32 v166, v173, v165, vcc
    v_mfma_f32_16x16x32_bf16 v[76:79], a[188:191], v[156:159], v[76:79]
    v_cndmask_b32 v182, v189, v181, vcc
    v_pk_fma_f32 v[32:33], v[192:193], v[160:161], v[32:33] op_sel:[0,0,0] op_sel_hi:[1,0,1] neg_lo:[0,1,0] neg_hi:[0,1,0]
    v_pk_fma_f32 v[34:35], v[194:195], v[160:161], v[34:35] op_sel:[0,0,0] op_sel_hi:[1,0,1] neg_lo:[0,1,0] neg_hi:[0,1,0]
    v_pk_fma_f32 v[44:45], v[192:193], v[168:169], v[44:45] op_sel:[0,0,0] op_sel_hi:[1,0,1] neg_lo:[0,1,0] neg_hi:[0,1,0]
    v_pk_fma_f32 v[46:47], v[194:195], v[168:169], v[46:47] op_sel:[0,0,0] op_sel_hi:[1,0,1] neg_lo:[0,1,0] neg_hi:[0,1,0]
    v_pk_fma_f32 v[36:37], v[196:197], v[160:161], v[36:37] op_sel:[0,0,0] op_sel_hi:[1,0,1] neg_lo:[0,1,0] neg_hi:[0,1,0]
    v_pk_fma_f32 v[38:39], v[198:199], v[160:161], v[38:39] op_sel:[0,0,0] op_sel_hi:[1,0,1] neg_lo:[0,1,0] neg_hi:[0,1,0]
    v_pk_fma_f32 v[48:49], v[196:197], v[168:169], v[48:49] op_sel:[0,0,0] op_sel_hi:[1,0,1] neg_lo:[0,1,0] neg_hi:[0,1,0]
    v_pk_fma_f32 v[50:51], v[198:199], v[168:169], v[50:51] op_sel:[0,0,0] op_sel_hi:[1,0,1] neg_lo:[0,1,0] neg_hi:[0,1,0]
    v_pk_fma_f32 v[40:41], v[200:201], v[160:161], v[40:41] op_sel:[0,0,0] op_sel_hi:[1,0,1] neg_lo:[0,1,0] neg_hi:[0,1,0]
    v_pk_fma_f32 v[42:43], v[202:203], v[160:161], v[42:43] op_sel:[0,0,0] op_sel_hi:[1,0,1] neg_lo:[0,1,0] neg_hi:[0,1,0]
    v_pk_fma_f32 v[52:53], v[200:201], v[168:169], v[52:53] op_sel:[0,0,0] op_sel_hi:[1,0,1] neg_lo:[0,1,0] neg_hi:[0,1,0]
    v_pk_fma_f32 v[54:55], v[202:203], v[168:169], v[54:55] op_sel:[0,0,0] op_sel_hi:[1,0,1] neg_lo:[0,1,0] neg_hi:[0,1,0]
    v_permlane32_swap_b32 v32, v44
    v_permlane32_swap_b32 v33, v45
    v_permlane32_swap_b32 v34, v46
    v_permlane32_swap_b32 v35, v47
    v_permlane32_swap_b32 v36, v48
    v_permlane32_swap_b32 v37, v49
    v_permlane32_swap_b32 v38, v50
    v_permlane32_swap_b32 v39, v51
    v_permlane32_swap_b32 v40, v52
    v_permlane32_swap_b32 v41, v53
    v_permlane32_swap_b32 v42, v54
    v_permlane32_swap_b32 v43, v55
    v_max_f32 v32, 0, v32
    v_max_f32 v33, 0, v33
    v_max_f32 v34, 0, v34
    v_max_f32 v35, 0, v35
    v_pk_mul_f32 v[32:33], v[32:33], v[44:45]
    v_pk_mul_f32 v[34:35], v[34:35], v[46:47]
    v_pk_mul_f32 v[32:33], v[32:33], v[162:163] op_sel:[0,0] op_sel_hi:[1,0]
    v_pk_mul_f32 v[34:35], v[34:35], v[162:163] op_sel:[0,0] op_sel_hi:[1,0]
    v_cvt_pk_bf16_f32 v44, v32, v33
    v_cvt_pk_bf16_f32 v45, v34, v35
    v_max_f32 v36, 0, v36
    v_max_f32 v37, 0, v37
    v_max_f32 v38, 0, v38
    v_max_f32 v39, 0, v39
    v_pk_mul_f32 v[36:37], v[36:37], v[48:49]
    v_pk_mul_f32 v[38:39], v[38:39], v[50:51]
    v_pk_mul_f32 v[36:37], v[36:37], v[162:163] op_sel:[0,0] op_sel_hi:[1,0]
    v_pk_mul_f32 v[38:39], v[38:39], v[162:163] op_sel:[0,0] op_sel_hi:[1,0]
    v_cvt_pk_bf16_f32 v46, v36, v37
    v_cvt_pk_bf16_f32 v47, v38, v39
    s_mul_i32 s71, s65, 393216
    s_mul_i32 s72, s66, 3072
    s_add_u32 s71, s71, s72
    s_add_u32 s71, s71, 5242880
    buffer_store_dwordx4 v[44:47], v12, s[32:35], s71 offen sc1
    v_max_f32 v40, 0, v40
    v_max_f32 v41, 0, v41
    v_max_f32 v42, 0, v42
    v_max_f32 v43, 0, v43
    v_pk_mul_f32 v[40:41], v[40:41], v[52:53]
    v_pk_mul_f32 v[42:43], v[42:43], v[54:55]
    v_pk_mul_f32 v[40:41], v[40:41], v[162:163] op_sel:[0,0] op_sel_hi:[1,0]
    v_pk_mul_f32 v[42:43], v[42:43], v[162:163] op_sel:[0,0] op_sel_hi:[1,0]
    v_cvt_pk_bf16_f32 v48, v40, v41
    v_cvt_pk_bf16_f32 v49, v42, v43
    v_pk_fma_f32 v[56:57], v[192:193], v[176:177], v[56:57] op_sel:[0,0,0] op_sel_hi:[1,0,1] neg_lo:[0,1,0] neg_hi:[0,1,0]
    v_pk_fma_f32 v[58:59], v[194:195], v[176:177], v[58:59] op_sel:[0,0,0] op_sel_hi:[1,0,1] neg_lo:[0,1,0] neg_hi:[0,1,0]
    v_pk_fma_f32 v[68:69], v[192:193], v[184:185], v[68:69] op_sel:[0,0,0] op_sel_hi:[1,0,1] neg_lo:[0,1,0] neg_hi:[0,1,0]
    v_pk_fma_f32 v[70:71], v[194:195], v[184:185], v[70:71] op_sel:[0,0,0] op_sel_hi:[1,0,1] neg_lo:[0,1,0] neg_hi:[0,1,0]
    v_pk_fma_f32 v[60:61], v[196:197], v[176:177], v[60:61] op_sel:[0,0,0] op_sel_hi:[1,0,1] neg_lo:[0,1,0] neg_hi:[0,1,0]
    v_pk_fma_f32 v[62:63], v[198:199], v[176:177], v[62:63] op_sel:[0,0,0] op_sel_hi:[1,0,1] neg_lo:[0,1,0] neg_hi:[0,1,0]
    v_pk_fma_f32 v[72:73], v[196:197], v[184:185], v[72:73] op_sel:[0,0,0] op_sel_hi:[1,0,1] neg_lo:[0,1,0] neg_hi:[0,1,0]
    v_pk_fma_f32 v[74:75], v[198:199], v[184:185], v[74:75] op_sel:[0,0,0] op_sel_hi:[1,0,1] neg_lo:[0,1,0] neg_hi:[0,1,0]
    v_pk_fma_f32 v[64:65], v[200:201], v[176:177], v[64:65] op_sel:[0,0,0] op_sel_hi:[1,0,1] neg_lo:[0,1,0] neg_hi:[0,1,0]
    v_pk_fma_f32 v[66:67], v[202:203], v[176:177], v[66:67] op_sel:[0,0,0] op_sel_hi:[1,0,1] neg_lo:[0,1,0] neg_hi:[0,1,0]
    v_pk_fma_f32 v[76:77], v[200:201], v[184:185], v[76:77] op_sel:[0,0,0] op_sel_hi:[1,0,1] neg_lo:[0,1,0] neg_hi:[0,1,0]
    v_pk_fma_f32 v[78:79], v[202:203], v[184:185], v[78:79] op_sel:[0,0,0] op_sel_hi:[1,0,1] neg_lo:[0,1,0] neg_hi:[0,1,0]
    v_permlane32_swap_b32 v56, v68
    v_permlane32_swap_b32 v57, v69
    v_permlane32_swap_b32 v58, v70
    v_permlane32_swap_b32 v59, v71
    v_permlane32_swap_b32 v60, v72
    v_permlane32_swap_b32 v61, v73
    v_permlane32_swap_b32 v62, v74
    v_permlane32_swap_b32 v63, v75
    v_permlane32_swap_b32 v64, v76
    v_permlane32_swap_b32 v65, v77
    v_permlane32_swap_b32 v66, v78
    v_permlane32_swap_b32 v67, v79
    v_max_f32 v56, 0, v56
    v_max_f32 v57, 0, v57
    v_max_f32 v58, 0, v58
    v_max_f32 v59, 0, v59
    v_pk_mul_f32 v[56:57], v[56:57], v[68:69]
    v_pk_mul_f32 v[58:59], v[58:59], v[70:71]
    v_pk_mul_f32 v[56:57], v[56:57], v[178:179] op_sel:[0,0] op_sel_hi:[1,0]
    v_pk_mul_f32 v[58:59], v[58:59], v[178:179] op_sel:[0,0] op_sel_hi:[1,0]
    v_cvt_pk_bf16_f32 v68, v56, v57
    v_cvt_pk_bf16_f32 v69, v58, v59
    v_max_f32 v60, 0, v60
    v_max_f32 v61, 0, v61
    v_max_f32 v62, 0, v62
    v_max_f32 v63, 0, v63
    v_pk_mul_f32 v[60:61], v[60:61], v[72:73]
    v_pk_mul_f32 v[62:63], v[62:63], v[74:75]
    v_pk_mul_f32 v[60:61], v[60:61], v[178:179] op_sel:[0,0] op_sel_hi:[1,0]
    v_pk_mul_f32 v[62:63], v[62:63], v[178:179] op_sel:[0,0] op_sel_hi:[1,0]
    v_cvt_pk_bf16_f32 v70, v60, v61
    v_cvt_pk_bf16_f32 v71, v62, v63
    s_mul_i32 s71, s65, 393216
    s_mul_i32 s72, s66, 3072
    s_add_u32 s71, s71, s72
    s_add_u32 s71, s71, 5292032
    buffer_store_dwordx4 v[68:71], v12, s[32:35], s71 offen sc1
    v_max_f32 v64, 0, v64
    v_max_f32 v65, 0, v65
    v_max_f32 v66, 0, v66
    v_max_f32 v67, 0, v67
    v_pk_mul_f32 v[64:65], v[64:65], v[76:77]
    v_pk_mul_f32 v[66:67], v[66:67], v[78:79]
    v_pk_mul_f32 v[64:65], v[64:65], v[178:179] op_sel:[0,0] op_sel_hi:[1,0]
    v_pk_mul_f32 v[66:67], v[66:67], v[178:179] op_sel:[0,0] op_sel_hi:[1,0]
    v_cvt_pk_bf16_f32 v50, v64, v65
    v_cvt_pk_bf16_f32 v51, v66, v67
    s_nop 0
    v_permlane16_swap_b32 v48, v50
    v_permlane16_swap_b32 v49, v51
    s_mul_i32 s71, s65, 393216
    s_mul_i32 s72, s66, 3072
    s_add_u32 s71, s71, s72
    s_add_u32 s71, s71, 5242880
    buffer_store_dwordx4 v[48:51], v13, s[32:35], s71 offen sc1
    s_waitcnt lgkmcnt(0)
    s_barrier
    v_add_u32 v14, 65536, v4
    ds_read_b128 v[128:131], v14 offset:0
    ds_read_b128 v[132:135], v14 offset:16384
    ds_read_b128 v[136:139], v14 offset:32768
    ds_read_b128 v[140:143], v14 offset:49152
    s_waitcnt lgkmcnt(0)
    v_mfma_f32_16x16x32_bf16 v[80:83], a[0:3], v[128:131], 0
    ds_read_b128 v[144:147], v14 offset:1024
    v_mfma_f32_16x16x32_bf16 v[84:87], a[4:7], v[128:131], 0
    s_mov_b32 s74, s16
    buffer_load_dwordx4 a[192:195], v4, s[32:35], s74 offen offset:0
    v_mfma_f32_16x16x32_bf16 v[88:91], a[8:11], v[128:131], 0
    v_mfma_f32_16x16x32_bf16 v[92:95], a[0:3], v[132:135], 0
    ds_read_b128 v[148:151], v14 offset:17408
    v_mfma_f32_16x16x32_bf16 v[96:99], a[4:7], v[132:135], 0
    v_mfma_f32_16x16x32_bf16 v[100:103], a[8:11], v[132:135], 0
    s_mov_b32 s74, s16
    buffer_load_dwordx4 a[196:199], v4, s[32:35], s74 offen offset:1024
    v_mfma_f32_16x16x32_bf16 v[104:107], a[0:3], v[136:139], 0
    ds_read_b128 v[152:155], v14 offset:33792
    v_mfma_f32_16x16x32_bf16 v[108:111], a[4:7], v[136:139], 0
    v_mfma_f32_16x16x32_bf16 v[112:115], a[8:11], v[136:139], 0
    v_mfma_f32_16x16x32_bf16 v[116:119], a[0:3], v[140:143], 0
    ds_read_b128 v[156:159], v14 offset:50176
    s_mov_b32 s74, s17
    buffer_load_dwordx4 a[200:203], v4, s[32:35], s74 offen offset:0
    v_mfma_f32_16x16x32_bf16 v[120:123], a[4:7], v[140:143], 0
    v_mfma_f32_16x16x32_bf16 v[124:127], a[8:11], v[140:143], 0
    s_waitcnt lgkmcnt(0)
    v_mfma_f32_16x16x32_bf16 v[80:83], a[12:15], v[144:147], v[80:83]
    ds_read_b128 v[128:131], v14 offset:2048
    v_mfma_f32_16x16x32_bf16 v[84:87], a[16:19], v[144:147], v[84:87]
    s_mov_b32 s74, s17
    buffer_load_dwordx4 a[204:207], v4, s[32:35], s74 offen offset:1024
    v_mfma_f32_16x16x32_bf16 v[88:91], a[20:23], v[144:147], v[88:91]
    v_mfma_f32_16x16x32_bf16 v[92:95], a[12:15], v[148:151], v[92:95]
    ds_read_b128 v[132:135], v14 offset:18432
    v_mfma_f32_16x16x32_bf16 v[96:99], a[16:19], v[148:151], v[96:99]
    v_mfma_f32_16x16x32_bf16 v[100:103], a[20:23], v[148:151], v[100:103]
    s_add_u32 s74, s14, 4096
    buffer_load_dwordx4 a[208:211], v4, s[32:35], s74 offen offset:0
    v_mfma_f32_16x16x32_bf16 v[104:107], a[12:15], v[152:155], v[104:107]
    ds_read_b128 v[136:139], v14 offset:34816
    v_mfma_f32_16x16x32_bf16 v[108:111], a[16:19], v[152:155], v[108:111]
    v_mfma_f32_16x16x32_bf16 v[112:115], a[20:23], v[152:155], v[112:115]
    v_mfma_f32_16x16x32_bf16 v[116:119], a[12:15], v[156:159], v[116:119]
    ds_read_b128 v[140:143], v14 offset:51200
    s_add_u32 s74, s14, 4096
    buffer_load_dwordx4 a[212:215], v4, s[32:35], s74 offen offset:1024
    v_mfma_f32_16x16x32_bf16 v[120:123], a[16:19], v[156:159], v[120:123]
    v_mfma_f32_16x16x32_bf16 v[124:127], a[20:23], v[156:159], v[124:127]
    s_waitcnt lgkmcnt(0)
    v_mfma_f32_16x16x32_bf16 v[80:83], a[24:27], v[128:131], v[80:83]
    ds_read_b128 v[144:147], v14 offset:3072
    v_mfma_f32_16x16x32_bf16 v[84:87], a[28:31], v[128:131], v[84:87]
    s_add_u32 s74, s15, 4096
    buffer_load_dwordx4 a[216:219], v4, s[32:35], s74 offen offset:0
    v_mfma_f32_16x16x32_bf16 v[88:91], a[32:35], v[128:131], v[88:91]
    v_mfma_f32_16x16x32_bf16 v[92:95], a[24:27], v[132:135], v[92:95]
    ds_read_b128 v[148:151], v14 offset:19456
    v_mfma_f32_16x16x32_bf16 v[96:99], a[28:31], v[132:135], v[96:99]
    v_mfma_f32_16x16x32_bf16 v[100:103], a[32:35], v[132:135], v[100:103]
    s_add_u32 s74, s15, 4096
    buffer_load_dwordx4 a[220:223], v4, s[32:35], s74 offen offset:1024
    v_mfma_f32_16x16x32_bf16 v[104:107], a[24:27], v[136:139], v[104:107]
    ds_read_b128 v[152:155], v14 offset:35840
    v_mfma_f32_16x16x32_bf16 v[108:111], a[28:31], v[136:139], v[108:111]
    v_mfma_f32_16x16x32_bf16 v[112:115], a[32:35], v[136:139], v[112:115]
    v_mfma_f32_16x16x32_bf16 v[116:119], a[24:27], v[140:143], v[116:119]
    ds_read_b128 v[156:159], v14 offset:52224
    s_add_u32 s74, s14, 8192
    buffer_load_dwordx4 a[224:227], v4, s[32:35], s74 offen offset:0
    v_mfma_f32_16x16x32_bf16 v[120:123], a[28:31], v[140:143], v[120:123]
    v_mfma_f32_16x16x32_bf16 v[124:127], a[32:35], v[140:143], v[124:127]
    s_waitcnt lgkmcnt(0)
    v_mfma_f32_16x16x32_bf16 v[80:83], a[36:39], v[144:147], v[80:83]
    ds_read_b128 v[128:131], v14 offset:4096
    v_mfma_f32_16x16x32_bf16 v[84:87], a[40:43], v[144:147], v[84:87]
    s_add_u32 s74, s14, 8192
    buffer_load_dwordx4 a[228:231], v4, s[32:35], s74 offen offset:1024
    v_mfma_f32_16x16x32_bf16 v[88:91], a[44:47], v[144:147], v[88:91]
    v_mfma_f32_16x16x32_bf16 v[92:95], a[36:39], v[148:151], v[92:95]
    ds_read_b128 v[132:135], v14 offset:20480
    v_mfma_f32_16x16x32_bf16 v[96:99], a[40:43], v[148:151], v[96:99]
    v_mfma_f32_16x16x32_bf16 v[100:103], a[44:47], v[148:151], v[100:103]
    s_add_u32 s74, s15, 8192
    buffer_load_dwordx4 a[232:235], v4, s[32:35], s74 offen offset:0
    v_mfma_f32_16x16x32_bf16 v[104:107], a[36:39], v[152:155], v[104:107]
    ds_read_b128 v[136:139], v14 offset:36864
    v_mfma_f32_16x16x32_bf16 v[108:111], a[40:43], v[152:155], v[108:111]
    v_mfma_f32_16x16x32_bf16 v[112:115], a[44:47], v[152:155], v[112:115]
    v_mfma_f32_16x16x32_bf16 v[116:119], a[36:39], v[156:159], v[116:119]
    ds_read_b128 v[140:143], v14 offset:53248
    s_add_u32 s74, s15, 8192
    buffer_load_dwordx4 a[236:239], v4, s[32:35], s74 offen offset:1024
    v_mfma_f32_16x16x32_bf16 v[120:123], a[40:43], v[156:159], v[120:123]
    v_mfma_f32_16x16x32_bf16 v[124:127], a[44:47], v[156:159], v[124:127]
    s_waitcnt lgkmcnt(0)
    v_mfma_f32_16x16x32_bf16 v[80:83], a[48:51], v[128:131], v[80:83]
    ds_read_b128 v[144:147], v14 offset:5120
    v_mfma_f32_16x16x32_bf16 v[84:87], a[52:55], v[128:131], v[84:87]
    s_add_u32 s74, s14, 12288
    buffer_load_dwordx4 a[240:243], v4, s[32:35], s74 offen offset:0
    v_mfma_f32_16x16x32_bf16 v[88:91], a[56:59], v[128:131], v[88:91]
    v_mfma_f32_16x16x32_bf16 v[92:95], a[48:51], v[132:135], v[92:95]
    ds_read_b128 v[148:151], v14 offset:21504
    v_mfma_f32_16x16x32_bf16 v[96:99], a[52:55], v[132:135], v[96:99]
    s_waitcnt vmcnt(13)
    s_add_u32 s74, s76, 5
    v_mov_b32 v8, s74
    v_mov_b32 v9, 0
    s_mov_b64 exec, 1
    s_cmp_eq_u32 s75, 1
    s_cbranch_scc1 L_hf11
    buffer_store_dword v8, v9, s[32:35], s61 offen sc1
    s_branch L_he11
L_hf11:
    buffer_store_dword v8, v9, s[32:35], s61 offen
L_he11:
    s_mov_b64 exec, -1
    v_mfma_f32_16x16x32_bf16 v[100:103], a[56:59], v[132:135], v[100:103]
    s_add_u32 s74, s14, 12288
    buffer_load_dwordx4 a[244:247], v4, s[32:35], s74 offen offset:1024
    v_mfma_f32_16x16x32_bf16 v[104:107], a[48:51], v[136:139], v[104:107]
    ds_read_b128 v[152:155], v14 offset:37888
    v_mfma_f32_16x16x32_bf16 v[108:111], a[52:55], v[136:139], v[108:111]
    v_mfma_f32_16x16x32_bf16 v[112:115], a[56:59], v[136:139], v[112:115]
    v_mfma_f32_16x16x32_bf16 v[116:119], a[48:51], v[140:143], v[116:119]
    ds_read_b128 v[156:159], v14 offset:54272
    s_add_u32 s74, s15, 12288
    buffer_load_dwordx4 a[248:251], v4, s[32:35], s74 offen offset:0
    v_mfma_f32_16x16x32_bf16 v[120:123], a[52:55], v[140:143], v[120:123]
    v_mfma_f32_16x16x32_bf16 v[124:127], a[56:59], v[140:143], v[124:127]
    s_waitcnt lgkmcnt(0)
    v_mfma_f32_16x16x32_bf16 v[80:83], a[60:63], v[144:147], v[80:83]
    ds_read_b128 v[128:131], v14 offset:6144
    v_mfma_f32_16x16x32_bf16 v[84:87], a[64:67], v[144:147], v[84:87]
    s_add_u32 s74, s15, 12288
    buffer_load_dwordx4 a[252:255], v4, s[32:35], s74 offen offset:1024
    v_mfma_f32_16x16x32_bf16 v[88:91], a[68:71], v[144:147], v[88:91]
    v_mfma_f32_16x16x32_bf16 v[92:95], a[60:63], v[148:151], v[92:95]
    ds_read_b128 v[132:135], v14 offset:22528
    v_mfma_f32_16x16x32_bf16 v[96:99], a[64:67], v[148:151], v[96:99]
    v_mfma_f32_16x16x32_bf16 v[100:103], a[68:71], v[148:151], v[100:103]
    s_add_u32 s74, s14, 16384
    buffer_load_dwordx4 v[208:211], v4, s[32:35], s74 offen offset:0
    v_mfma_f32_16x16x32_bf16 v[104:107], a[60:63], v[152:155], v[104:107]
    ds_read_b128 v[136:139], v14 offset:38912
    v_mfma_f32_16x16x32_bf16 v[108:111], a[64:67], v[152:155], v[108:111]
    v_mfma_f32_16x16x32_bf16 v[112:115], a[68:71], v[152:155], v[112:115]
    v_mfma_f32_16x16x32_bf16 v[116:119], a[60:63], v[156:159], v[116:119]
    ds_read_b128 v[140:143], v14 offset:55296
    s_add_u32 s74, s14, 16384
    buffer_load_dwordx4 v[212:215], v4, s[32:35], s74 offen offset:1024
    v_mfma_f32_16x16x32_bf16 v[120:123], a[64:67], v[156:159], v[120:123]
    v_mfma_f32_16x16x32_bf16 v[124:127], a[68:71], v[156:159], v[124:127]
    s_waitcnt lgkmcnt(0)
    v_mfma_f32_16x16x32_bf16 v[80:83], a[72:75], v[128:131], v[80:83]
    ds_read_b128 v[144:147], v14 offset:7168
    v_mfma_f32_16x16x32_bf16 v[84:87], a[76:79], v[128:131], v[84:87]
    s_add_u32 s74, s15, 16384
    buffer_load_dwordx4 v[216:219], v4, s[32:35], s74 offen offset:0
    v_mfma_f32_16x16x32_bf16 v[88:91], a[80:83], v[128:131], v[88:91]
    v_mfma_f32_16x16x32_bf16 v[92:95], a[72:75], v[132:135], v[92:95]
    ds_read_b128 v[148:151], v14 offset:23552
    v_mfma_f32_16x16x32_bf16 v[96:99], a[76:79], v[132:135], v[96:99]
    v_mfma_f32_16x16x32_bf16 v[100:103], a[80:83], v[132:135], v[100:103]
    s_add_u32 s74, s15, 16384
    buffer_load_dwordx4 v[220:223], v4, s[32:35], s74 offen offset:1024
    v_mfma_f32_16x16x32_bf16 v[104:107], a[72:75], v[136:139], v[104:107]
    ds_read_b128 v[152:155], v14 offset:39936
    v_mfma_f32_16x16x32_bf16 v[108:111], a[76:79], v[136:139], v[108:111]
    v_mfma_f32_16x16x32_bf16 v[112:115], a[80:83], v[136:139], v[112:115]
    v_mfma_f32_16x16x32_bf16 v[116:119], a[72:75], v[140:143], v[116:119]
    ds_read_b128 v[156:159], v14 offset:56320
    s_add_u32 s74, s14, 20480
    buffer_load_dwordx4 v[224:227], v4, s[32:35], s74 offen offset:0
    v_mfma_f32_16x16x32_bf16 v[120:123], a[76:79], v[140:143], v[120:123]
    v_mfma_f32_16x16x32_bf16 v[124:127], a[80:83], v[140:143], v[124:127]
    s_waitcnt lgkmcnt(0)
    v_mfma_f32_16x16x32_bf16 v[80:83], a[84:87], v[144:147], v[80:83]
    ds_read_b128 v[128:131], v14 offset:8192
    v_mfma_f32_16x16x32_bf16 v[84:87], a[88:91], v[144:147], v[84:87]
    s_add_u32 s74, s14, 20480
    buffer_load_dwordx4 v[228:231], v4, s[32:35], s74 offen offset:1024
    v_mfma_f32_16x16x32_bf16 v[88:91], a[92:95], v[144:147], v[88:91]
    v_mfma_f32_16x16x32_bf16 v[92:95], a[84:87], v[148:151], v[92:95]
    ds_read_b128 v[132:135], v14 offset:24576
    v_mfma_f32_16x16x32_bf16 v[96:99], a[88:91], v[148:151], v[96:99]
    v_mfma_f32_16x16x32_bf16 v[100:103], a[92:95], v[148:151], v[100:103]
    s_add_u32 s74, s15, 20480
    buffer_load_dwordx4 v[232:235], v4, s[32:35], s74 offen offset:0
    v_mfma_f32_16x16x32_bf16 v[104:107], a[84:87], v[152:155], v[104:107]
    ds_read_b128 v[136:139], v14 offset:40960
    v_mfma_f32_16x16x32_bf16 v[108:111], a[88:91], v[152:155], v[108:111]
    v_mfma_f32_16x16x32_bf16 v[112:115], a[92:95], v[152:155], v[112:115]
    v_mfma_f32_16x16x32_bf16 v[116:119], a[84:87], v[156:159], v[116:119]
    ds_read_b128 v[140:143], v14 offset:57344
    s_add_u32 s74, s15, 20480
    buffer_load_dwordx4 v[236:239], v4, s[32:35], s74 offen offset:1024
    v_mfma_f32_16x16x32_bf16 v[120:123], a[88:91], v[156:159], v[120:123]
    v_mfma_f32_16x16x32_bf16 v[124:127], a[92:95], v[156:159], v[124:127]
    s_waitcnt lgkmcnt(0)
    v_mfma_f32_16x16x32_bf16 v[80:83], a[96:99], v[128:131], v[80:83]
    ds_read_b128 v[144:147], v14 offset:9216
    v_mfma_f32_16x16x32_bf16 v[84:87], a[100:103], v[128:131], v[84:87]
    s_add_u32 s74, s14, 24576
    buffer_load_dwordx4 v[240:243], v4, s[32:35], s74 offen offset:0
    v_mfma_f32_16x16x32_bf16 v[88:91], a[104:107], v[128:131], v[88:91]
    v_mfma_f32_16x16x32_bf16 v[92:95], a[96:99], v[132:135], v[92:95]
    ds_read_b128 v[148:151], v14 offset:25600
    v_mfma_f32_16x16x32_bf16 v[96:99], a[100:103], v[132:135], v[96:99]
    v_mfma_f32_16x16x32_bf16 v[100:103], a[104:107], v[132:135], v[100:103]
    s_add_u32 s74, s14, 24576
    buffer_load_dwordx4 v[244:247], v4, s[32:35], s74 offen offset:1024
    v_mfma_f32_16x16x32_bf16 v[104:107], a[96:99], v[136:139], v[104:107]
    ds_read_b128 v[152:155], v14 offset:41984
    v_mfma_f32_16x16x32_bf16 v[108:111], a[100:103], v[136:139], v[108:111]
    v_mfma_f32_16x16x32_bf16 v[112:115], a[104:107], v[136:139], v[112:115]
    v_mfma_f32_16x16x32_bf16 v[116:119], a[96:99], v[140:143], v[116:119]
    ds_read_b128 v[156:159], v14 offset:58368
    s_add_u32 s74, s15, 24576
    buffer_load_dwordx4 v[248:251], v4, s[32:35], s74 offen offset:0
    v_mfma_f32_16x16x32_bf16 v[120:123], a[100:103], v[140:143], v[120:123]
    v_mfma_f32_16x16x32_bf16 v[124:127], a[104:107], v[140:143], v[124:127]
    s_waitcnt lgkmcnt(0)
    v_mfma_f32_16x16x32_bf16 v[80:83], a[108:111], v[144:147], v[80:83]
    ds_read_b128 v[128:131], v14 offset:10240
    v_mfma_f32_16x16x32_bf16 v[84:87], a[112:115], v[144:147], v[84:87]
    s_add_u32 s74, s15, 24576
    buffer_load_dwordx4 v[252:255], v4, s[32:35], s74 offen offset:1024
    v_mfma_f32_16x16x32_bf16 v[88:91], a[116:119], v[144:147], v[88:91]
    v_mfma_f32_16x16x32_bf16 v[92:95], a[108:111], v[148:151], v[92:95]
    ds_read_b128 v[132:135], v14 offset:26624
    v_mfma_f32_16x16x32_bf16 v[96:99], a[112:115], v[148:151], v[96:99]
    v_mfma_f32_16x16x32_bf16 v[100:103], a[116:119], v[148:151], v[100:103]
    s_add_u32 s74, s14, 28672
    buffer_load_dwordx4 a[0:3], v4, s[32:35], s74 offen offset:0
    v_mfma_f32_16x16x32_bf16 v[104:107], a[108:111], v[152:155], v[104:107]
    ds_read_b128 v[136:139], v14 offset:43008
    v_mfma_f32_16x16x32_bf16 v[108:111], a[112:115], v[152:155], v[108:111]
    v_mfma_f32_16x16x32_bf16 v[112:115], a[116:119], v[152:155], v[112:115]
    v_mfma_f32_16x16x32_bf16 v[116:119], a[108:111], v[156:159], v[116:119]
    ds_read_b128 v[140:143], v14 offset:59392
    s_add_u32 s74, s14, 28672
    buffer_load_dwordx4 a[4:7], v4, s[32:35], s74 offen offset:1024
    v_mfma_f32_16x16x32_bf16 v[120:123], a[112:115], v[156:159], v[120:123]
    v_mfma_f32_16x16x32_bf16 v[124:127], a[116:119], v[156:159], v[124:127]
    s_waitcnt lgkmcnt(0)
    v_mfma_f32_16x16x32_bf16 v[80:83], a[120:123], v[128:131], v[80:83]
    ds_read_b128 v[144:147], v14 offset:11264
    v_mfma_f32_16x16x32_bf16 v[84:87], a[124:127], v[128:131], v[84:87]
    s_add_u32 s74, s15, 28672
    buffer_load_dwordx4 a[8:11], v4, s[32:35], s74 offen offset:0
    v_mfma_f32_16x16x32_bf16 v[88:91], a[128:131], v[128:131], v[88:91]
    v_mfma_f32_16x16x32_bf16 v[92:95], a[120:123], v[132:135], v[92:95]
    ds_read_b128 v[148:151], v14 offset:27648
    v_mfma_f32_16x16x32_bf16 v[96:99], a[124:127], v[132:135], v[96:99]
    v_mfma_f32_16x16x32_bf16 v[100:103], a[128:131], v[132:135], v[100:103]
    s_add_u32 s74, s15, 28672
    buffer_load_dwordx4 a[12:15], v4, s[32:35], s74 offen offset:1024
    v_mfma_f32_16x16x32_bf16 v[104:107], a[120:123], v[136:139], v[104:107]
    ds_read_b128 v[152:155], v14 offset:44032
    v_mfma_f32_16x16x32_bf16 v[108:111], a[124:127], v[136:139], v[108:111]
    v_mfma_f32_16x16x32_bf16 v[112:115], a[128:131], v[136:139], v[112:115]
    v_mfma_f32_16x16x32_bf16 v[116:119], a[120:123], v[140:143], v[116:119]
    ds_read_b128 v[156:159], v14 offset:60416
    s_add_u32 s74, s14, 32768
    buffer_load_dwordx4 a[16:19], v4, s[32:35], s74 offen offset:0
    v_mfma_f32_16x16x32_bf16 v[120:123], a[124:127], v[140:143], v[120:123]
    v_mfma_f32_16x16x32_bf16 v[124:127], a[128:131], v[140:143], v[124:127]
    s_waitcnt lgkmcnt(0)
    v_mfma_f32_16x16x32_bf16 v[80:83], a[132:135], v[144:147], v[80:83]
    ds_read_b128 v[128:131], v14 offset:12288
    v_mfma_f32_16x16x32_bf16 v[84:87], a[136:139], v[144:147], v[84:87]
    s_add_u32 s74, s14, 32768
    buffer_load_dwordx4 a[20:23], v4, s[32:35], s74 offen offset:1024
    v_mfma_f32_16x16x32_bf16 v[88:91], a[140:143], v[144:147], v[88:91]
    v_mfma_f32_16x16x32_bf16 v[92:95], a[132:135], v[148:151], v[92:95]
    ds_read_b128 v[132:135], v14 offset:28672
    v_mfma_f32_16x16x32_bf16 v[96:99], a[136:139], v[148:151], v[96:99]
    v_mfma_f32_16x16x32_bf16 v[100:103], a[140:143], v[148:151], v[100:103]
    s_add_u32 s74, s15, 32768
    buffer_load_dwordx4 a[24:27], v4, s[32:35], s74 offen offset:0
    v_mfma_f32_16x16x32_bf16 v[104:107], a[132:135], v[152:155], v[104:107]
    ds_read_b128 v[136:139], v14 offset:45056
    v_mfma_f32_16x16x32_bf16 v[108:111], a[136:139], v[152:155], v[108:111]
    v_mfma_f32_16x16x32_bf16 v[112:115], a[140:143], v[152:155], v[112:115]
    v_mfma_f32_16x16x32_bf16 v[116:119], a[132:135], v[156:159], v[116:119]
    ds_read_b128 v[140:143], v14 offset:61440
    s_add_u32 s74, s15, 32768
    buffer_load_dwordx4 a[28:31], v4, s[32:35], s74 offen offset:1024
    v_mfma_f32_16x16x32_bf16 v[120:123], a[136:139], v[156:159], v[120:123]
    v_mfma_f32_16x16x32_bf16 v[124:127], a[140:143], v[156:159], v[124:127]
    s_waitcnt lgkmcnt(0)
    v_mfma_f32_16x16x32_bf16 v[80:83], a[144:147], v[128:131], v[80:83]
    ds_read_b128 v[144:147], v14 offset:13312
    v_mfma_f32_16x16x32_bf16 v[84:87], a[148:151], v[128:131], v[84:87]
    s_add_u32 s74, s14, 36864
    buffer_load_dwordx4 a[32:35], v4, s[32:35], s74 offen offset:0
    v_mfma_f32_16x16x32_bf16 v[88:91], a[152:155], v[128:131], v[88:91]
    v_mfma_f32_16x16x32_bf16 v[92:95], a[144:147], v[132:135], v[92:95]
    ds_read_b128 v[148:151], v14 offset:29696
    v_mfma_f32_16x16x32_bf16 v[96:99], a[148:151], v[132:135], v[96:99]
    v_mfma_f32_16x16x32_bf16 v[100:103], a[152:155], v[132:135], v[100:103]
    s_add_u32 s74, s14, 36864
    buffer_load_dwordx4 a[36:39], v4, s[32:35], s74 offen offset:1024
    v_mfma_f32_16x16x32_bf16 v[104:107], a[144:147], v[136:139], v[104:107]
    ds_read_b128 v[152:155], v14 offset:46080
    v_mfma_f32_16x16x32_bf16 v[108:111], a[148:151], v[136:139], v[108:111]
    v_mfma_f32_16x16x32_bf16 v[112:115], a[152:155], v[136:139], v[112:115]
    v_mfma_f32_16x16x32_bf16 v[116:119], a[144:147], v[140:143], v[116:119]
    ds_read_b128 v[156:159], v14 offset:62464
    s_add_u32 s74, s15, 36864
    buffer_load_dwordx4 a[40:43], v4, s[32:35], s74 offen offset:0
    v_mfma_f32_16x16x32_bf16 v[120:123], a[148:151], v[140:143], v[120:123]
    v_mfma_f32_16x16x32_bf16 v[124:127], a[152:155], v[140:143], v[124:127]
    s_waitcnt lgkmcnt(0)
    v_mfma_f32_16x16x32_bf16 v[80:83], a[156:159], v[144:147], v[80:83]
    ds_read_b128 v[128:131], v14 offset:14336
    v_mfma_f32_16x16x32_bf16 v[84:87], a[160:163], v[144:147], v[84:87]
    s_add_u32 s74, s15, 36864
    buffer_load_dwordx4 a[44:47], v4, s[32:35], s74 offen offset:1024
    v_mfma_f32_16x16x32_bf16 v[88:91], a[164:167], v[144:147], v[88:91]
    v_mfma_f32_16x16x32_bf16 v[92:95], a[156:159], v[148:151], v[92:95]
    ds_read_b128 v[132:135], v14 offset:30720
    v_mfma_f32_16x16x32_bf16 v[96:99], a[160:163], v[148:151], v[96:99]
    v_mfma_f32_16x16x32_bf16 v[100:103], a[164:167], v[148:151], v[100:103]
    s_add_u32 s74, s14, 40960
    buffer_load_dwordx4 a[48:51], v4, s[32:35], s74 offen offset:0
    v_mfma_f32_16x16x32_bf16 v[104:107], a[156:159], v[152:155], v[104:107]
    ds_read_b128 v[136:139], v14 offset:47104
    v_mfma_f32_16x16x32_bf16 v[108:111], a[160:163], v[152:155], v[108:111]
    v_mfma_f32_16x16x32_bf16 v[112:115], a[164:167], v[152:155], v[112:115]
    v_mfma_f32_16x16x32_bf16 v[116:119], a[156:159], v[156:159], v[116:119]
    ds_read_b128 v[140:143], v14 offset:63488
    s_add_u32 s74, s14, 40960
    buffer_load_dwordx4 a[52:55], v4, s[32:35], s74 offen offset:1024
    v_mfma_f32_16x16x32_bf16 v[120:123], a[160:163], v[156:159], v[120:123]
    v_mfma_f32_16x16x32_bf16 v[124:127], a[164:167], v[156:159], v[124:127]
    s_waitcnt lgkmcnt(0)
    v_mfma_f32_16x16x32_bf16 v[80:83], a[168:171], v[128:131], v[80:83]
    ds_read_b128 v[144:147], v14 offset:15360
    v_mfma_f32_16x16x32_bf16 v[84:87], a[172:175], v[128:131], v[84:87]
    s_add_u32 s74, s15, 40960
    buffer_load_dwordx4 a[56:59], v4, s[32:35], s74 offen offset:0
    v_mfma_f32_16x16x32_bf16 v[88:91], a[176:179], v[128:131], v[88:91]
    v_mfma_f32_16x16x32_bf16 v[92:95], a[168:171], v[132:135], v[92:95]
    ds_read_b128 v[148:151], v14 offset:31744
    v_mfma_f32_16x16x32_bf16 v[96:99], a[172:175], v[132:135], v[96:99]
    v_mfma_f32_16x16x32_bf16 v[100:103], a[176:179], v[132:135], v[100:103]
    s_add_u32 s74, s15, 40960
    buffer_load_dwordx4 a[60:63], v4, s[32:35], s74 offen offset:1024
    v_mfma_f32_16x16x32_bf16 v[104:107], a[168:171], v[136:139], v[104:107]
    ds_read_b128 v[152:155], v14 offset:48128
    v_mfma_f32_16x16x32_bf16 v[108:111], a[172:175], v[136:139], v[108:111]
    v_mfma_f32_16x16x32_bf16 v[112:115], a[176:179], v[136:139], v[112:115]
    v_mfma_f32_16x16x32_bf16 v[116:119], a[168:171], v[140:143], v[116:119]
    ds_read_b128 v[156:159], v14 offset:64512
    v_mfma_f32_16x16x32_bf16 v[120:123], a[172:175], v[140:143], v[120:123]
    v_mfma_f32_16x16x32_bf16 v[124:127], a[176:179], v[140:143], v[124:127]
    s_waitcnt lgkmcnt(0)
    v_mfma_f32_16x16x32_bf16 v[80:83], a[180:183], v[144:147], v[80:83]
    v_mfma_f32_16x16x32_bf16 v[84:87], a[184:187], v[144:147], v[84:87]
    v_mfma_f32_16x16x32_bf16 v[88:91], a[188:191], v[144:147], v[88:91]
    v_mfma_f32_16x16x32_bf16 v[92:95], a[180:183], v[148:151], v[92:95]
    v_mfma_f32_16x16x32_bf16 v[96:99], a[184:187], v[148:151], v[96:99]
    v_mfma_f32_16x16x32_bf16 v[100:103], a[188:191], v[148:151], v[100:103]
    v_mfma_f32_16x16x32_bf16 v[104:107], a[180:183], v[152:155], v[104:107]
    v_mfma_f32_16x16x32_bf16 v[108:111], a[184:187], v[152:155], v[108:111]
    v_mfma_f32_16x16x32_bf16 v[112:115], a[188:191], v[152:155], v[112:115]
    v_mfma_f32_16x16x32_bf16 v[116:119], a[180:183], v[156:159], v[116:119]
    v_mfma_f32_16x16x32_bf16 v[120:123], a[184:187], v[156:159], v[120:123]
    v_mfma_f32_16x16x32_bf16 v[124:127], a[188:191], v[156:159], v[124:127]
    buffer_load_dword v6, v7, s[32:35], s77 offen sc1
    v_pk_fma_f32 v[80:81], v[192:193], v[164:165], v[80:81] op_sel:[0,0,0] op_sel_hi:[1,0,1] neg_lo:[0,1,0] neg_hi:[0,1,0]
    v_pk_fma_f32 v[82:83], v[194:195], v[164:165], v[82:83] op_sel:[0,0,0] op_sel_hi:[1,0,1] neg_lo:[0,1,0] neg_hi:[0,1,0]
    v_pk_fma_f32 v[92:93], v[192:193], v[172:173], v[92:93] op_sel:[0,0,0] op_sel_hi:[1,0,1] neg_lo:[0,1,0] neg_hi:[0,1,0]
    v_pk_fma_f32 v[94:95], v[194:195], v[172:173], v[94:95] op_sel:[0,0,0] op_sel_hi:[1,0,1] neg_lo:[0,1,0] neg_hi:[0,1,0]
    v_pk_fma_f32 v[84:85], v[196:197], v[164:165], v[84:85] op_sel:[0,0,0] op_sel_hi:[1,0,1] neg_lo:[0,1,0] neg_hi:[0,1,0]
    v_pk_fma_f32 v[86:87], v[198:199], v[164:165], v[86:87] op_sel:[0,0,0] op_sel_hi:[1,0,1] neg_lo:[0,1,0] neg_hi:[0,1,0]
    v_pk_fma_f32 v[96:97], v[196:197], v[172:173], v[96:97] op_sel:[0,0,0] op_sel_hi:[1,0,1] neg_lo:[0,1,0] neg_hi:[0,1,0]
    v_pk_fma_f32 v[98:99], v[198:199], v[172:173], v[98:99] op_sel:[0,0,0] op_sel_hi:[1,0,1] neg_lo:[0,1,0] neg_hi:[0,1,0]
    v_pk_fma_f32 v[88:89], v[200:201], v[164:165], v[88:89] op_sel:[0,0,0] op_sel_hi:[1,0,1] neg_lo:[0,1,0] neg_hi:[0,1,0]
    v_pk_fma_f32 v[90:91], v[202:203], v[164:165], v[90:91] op_sel:[0,0,0] op_sel_hi:[1,0,1] neg_lo:[0,1,0] neg_hi:[0,1,0]
    v_pk_fma_f32 v[100:101], v[200:201], v[172:173], v[100:101] op_sel:[0,0,0] op_sel_hi:[1,0,1] neg_lo:[0,1,0] neg_hi:[0,1,0]
    v_pk_fma_f32 v[102:103], v[202:203], v[172:173], v[102:103] op_sel:[0,0,0] op_sel_hi:[1,0,1] neg_lo:[0,1,0] neg_hi:[0,1,0]
    v_permlane32_swap_b32 v80, v92
    v_permlane32_swap_b32 v81, v93
    v_permlane32_swap_b32 v82, v94
    v_permlane32_swap_b32 v83, v95
    v_permlane32_swap_b32 v84, v96
    v_permlane32_swap_b32 v85, v97
    v_permlane32_swap_b32 v86, v98
    v_permlane32_swap_b32 v87, v99
    v_permlane32_swap_b32 v88, v100
    v_permlane32_swap_b32 v89, v101
    v_permlane32_swap_b32 v90, v102
    v_permlane32_swap_b32 v91, v103
    v_max_f32 v80, 0, v80
    v_max_f32 v81, 0, v81
    v_max_f32 v82, 0, v82
    v_max_f32 v83, 0, v83
    v_pk_mul_f32 v[80:81], v[80:81], v[92:93]
    v_pk_mul_f32 v[82:83], v[82:83], v[94:95]
    v_pk_mul_f32 v[80:81], v[80:81], v[166:167] op_sel:[0,0] op_sel_hi:[1,0]
    v_pk_mul_f32 v[82:83], v[82:83], v[166:167] op_sel:[0,0] op_sel_hi:[1,0]
    v_cvt_pk_bf16_f32 v92, v80, v81
    v_cvt_pk_bf16_f32 v93, v82, v83
    v_max_f32 v84, 0, v84
    v_max_f32 v85, 0, v85
    v_max_f32 v86, 0, v86
    v_max_f32 v87, 0, v87
    v_pk_mul_f32 v[84:85], v[84:85], v[96:97]
    v_pk_mul_f32 v[86:87], v[86:87], v[98:99]
    v_pk_mul_f32 v[84:85], v[84:85], v[166:167] op_sel:[0,0] op_sel_hi:[1,0]
    v_pk_mul_f32 v[86:87], v[86:87], v[166:167] op_sel:[0,0] op_sel_hi:[1,0]
    v_cvt_pk_bf16_f32 v94, v84, v85
    v_cvt_pk_bf16_f32 v95, v86, v87
    s_mul_i32 s71, s65, 393216
    s_mul_i32 s72, s66, 3072
    s_add_u32 s71, s71, s72
    s_add_u32 s71, s71, 5341184
    buffer_store_dwordx4 v[92:95], v12, s[32:35], s71 offen sc1
    v_max_f32 v88, 0, v88
    v_max_f32 v89, 0, v89
    v_max_f32 v90, 0, v90
    v_max_f32 v91, 0, v91
    v_pk_mul_f32 v[88:89], v[88:89], v[100:101]
    v_pk_mul_f32 v[90:91], v[90:91], v[102:103]
    v_pk_mul_f32 v[88:89], v[88:89], v[166:167] op_sel:[0,0] op_sel_hi:[1,0]
    v_pk_mul_f32 v[90:91], v[90:91], v[166:167] op_sel:[0,0] op_sel_hi:[1,0]
    v_cvt_pk_bf16_f32 v96, v88, v89
    v_cvt_pk_bf16_f32 v97, v90, v91
    v_pk_fma_f32 v[104:105], v[192:193], v[180:181], v[104:105] op_sel:[0,0,0] op_sel_hi:[1,0,1] neg_lo:[0,1,0] neg_hi:[0,1,0]
    v_pk_fma_f32 v[106:107], v[194:195], v[180:181], v[106:107] op_sel:[0,0,0] op_sel_hi:[1,0,1] neg_lo:[0,1,0] neg_hi:[0,1,0]
    v_pk_fma_f32 v[116:117], v[192:193], v[188:189], v[116:117] op_sel:[0,0,0] op_sel_hi:[1,0,1] neg_lo:[0,1,0] neg_hi:[0,1,0]
    v_pk_fma_f32 v[118:119], v[194:195], v[188:189], v[118:119] op_sel:[0,0,0] op_sel_hi:[1,0,1] neg_lo:[0,1,0] neg_hi:[0,1,0]
    v_pk_fma_f32 v[108:109], v[196:197], v[180:181], v[108:109] op_sel:[0,0,0] op_sel_hi:[1,0,1] neg_lo:[0,1,0] neg_hi:[0,1,0]
    v_pk_fma_f32 v[110:111], v[198:199], v[180:181], v[110:111] op_sel:[0,0,0] op_sel_hi:[1,0,1] neg_lo:[0,1,0] neg_hi:[0,1,0]
    v_pk_fma_f32 v[120:121], v[196:197], v[188:189], v[120:121] op_sel:[0,0,0] op_sel_hi:[1,0,1] neg_lo:[0,1,0] neg_hi:[0,1,0]
    v_pk_fma_f32 v[122:123], v[198:199], v[188:189], v[122:123] op_sel:[0,0,0] op_sel_hi:[1,0,1] neg_lo:[0,1,0] neg_hi:[0,1,0]
    v_pk_fma_f32 v[112:113], v[200:201], v[180:181], v[112:113] op_sel:[0,0,0] op_sel_hi:[1,0,1] neg_lo:[0,1,0] neg_hi:[0,1,0]
    v_pk_fma_f32 v[114:115], v[202:203], v[180:181], v[114:115] op_sel:[0,0,0] op_sel_hi:[1,0,1] neg_lo:[0,1,0] neg_hi:[0,1,0]
    v_pk_fma_f32 v[124:125], v[200:201], v[188:189], v[124:125] op_sel:[0,0,0] op_sel_hi:[1,0,1] neg_lo:[0,1,0] neg_hi:[0,1,0]
    v_pk_fma_f32 v[126:127], v[202:203], v[188:189], v[126:127] op_sel:[0,0,0] op_sel_hi:[1,0,1] neg_lo:[0,1,0] neg_hi:[0,1,0]
    v_permlane32_swap_b32 v104, v116
    v_permlane32_swap_b32 v105, v117
    v_permlane32_swap_b32 v106, v118
    v_permlane32_swap_b32 v107, v119
    v_permlane32_swap_b32 v108, v120
    v_permlane32_swap_b32 v109, v121
    v_permlane32_swap_b32 v110, v122
    v_permlane32_swap_b32 v111, v123
    v_permlane32_swap_b32 v112, v124
    v_permlane32_swap_b32 v113, v125
    v_permlane32_swap_b32 v114, v126
    v_permlane32_swap_b32 v115, v127
    v_max_f32 v104, 0, v104
    v_max_f32 v105, 0, v105
    v_max_f32 v106, 0, v106
    v_max_f32 v107, 0, v107
    v_pk_mul_f32 v[104:105], v[104:105], v[116:117]
    v_pk_mul_f32 v[106:107], v[106:107], v[118:119]
    v_pk_mul_f32 v[104:105], v[104:105], v[182:183] op_sel:[0,0] op_sel_hi:[1,0]
    v_pk_mul_f32 v[106:107], v[106:107], v[182:183] op_sel:[0,0] op_sel_hi:[1,0]
    v_cvt_pk_bf16_f32 v116, v104, v105
    v_cvt_pk_bf16_f32 v117, v106, v107
    v_max_f32 v108, 0, v108
    v_max_f32 v109, 0, v109
    v_max_f32 v110, 0, v110
    v_max_f32 v111, 0, v111
    v_pk_mul_f32 v[108:109], v[108:109], v[120:121]
    v_pk_mul_f32 v[110:111], v[110:111], v[122:123]
    v_pk_mul_f32 v[108:109], v[108:109], v[182:183] op_sel:[0,0] op_sel_hi:[1,0]
    v_pk_mul_f32 v[110:111], v[110:111], v[182:183] op_sel:[0,0] op_sel_hi:[1,0]
    v_cvt_pk_bf16_f32 v118, v108, v109
    v_cvt_pk_bf16_f32 v119, v110, v111
    s_mul_i32 s71, s65, 393216
    s_mul_i32 s72, s66, 3072
    s_add_u32 s71, s71, s72
    s_add_u32 s71, s71, 5390336
    buffer_store_dwordx4 v[116:119], v12, s[32:35], s71 offen sc1
    v_max_f32 v112, 0, v112
    v_max_f32 v113, 0, v113
    v_max_f32 v114, 0, v114
    v_max_f32 v115, 0, v115
    v_pk_mul_f32 v[112:113], v[112:113], v[124:125]
    v_pk_mul_f32 v[114:115], v[114:115], v[126:127]
    v_pk_mul_f32 v[112:113], v[112:113], v[182:183] op_sel:[0,0] op_sel_hi:[1,0]
    v_pk_mul_f32 v[114:115], v[114:115], v[182:183] op_sel:[0,0] op_sel_hi:[1,0]
    v_cvt_pk_bf16_f32 v98, v112, v113
    v_cvt_pk_bf16_f32 v99, v114, v115
    s_nop 0
    v_permlane16_swap_b32 v96, v98
    v_permlane16_swap_b32 v97, v99
    s_mul_i32 s71, s65, 393216
    s_mul_i32 s72, s66, 3072
    s_add_u32 s71, s71, s72
    s_add_u32 s71, s71, 5341184
    buffer_store_dwordx4 v[96:99], v13, s[32:35], s71 offen sc1
    s_waitcnt vmcnt(3)
    s_nop 1
    s_mov_b32 s78, 0
    s_add_u32 s74, s76, 5
L_wait12:
    v_subrev_u32 v6, s74, v6
    v_cmp_lt_u32 vcc, 15, v6
    s_nop 1
    s_and_b64 vcc, vcc, -1
    s_cbranch_scc0 L_go12
    buffer_load_dword v6, v7, s[32:35], s77 offen sc1
    s_waitcnt vmcnt(0)
    s_add_u32 s78, s78, 1
    s_cmp_lt_u32 s78, 0x40000
    s_cbranch_scc1 L_wait12
L_go12:
    s_nop 1
    s_xor_b32 s71, s63, 0
    s_lshl_b32 s72, s69, 2
    s_add_u32 s71, s71, s72
    s_add_u32 s71, s71, 0
    s_mul_i32 s71, s71, 48
    s_mov_b32 s72, s79
    s_add_u32 s71, s71, s72
    s_lshl_b32 s71, s71, 10
    s_add_u32 s71, s71, 5242880
    buffer_load_dwordx4 a[64:67], v4, s[32:35], s71 offen offset:0
    buffer_load_dwordx4 a[68:71], v4, s[32:35], s71 offen offset:1024
    buffer_load_dwordx4 a[72:75], v4, s[32:35], s71 offen offset:2048
    buffer_load_dwordx4 a[76:79], v4, s[32:35], s71 offen offset:3072
    s_add_u32 s71, s71, 4096
    buffer_load_dwordx4 a[80:83], v4, s[32:35], s71 offen offset:0
    buffer_load_dwordx4 a[84:87], v4, s[32:35], s71 offen offset:1024
    buffer_load_dwordx4 a[88:91], v4, s[32:35], s71 offen offset:2048
    buffer_load_dwordx4 a[92:95], v4, s[32:35], s71 offen offset:3072
    s_waitcnt vmcnt(8)
    s_add_u32 s74, s76, 6
    v_mov_b32 v8, s74
    v_mov_b32 v9, 0
    s_mov_b64 exec, 1
    s_cmp_eq_u32 s75, 1
    s_cbranch_scc1 L_hf13
    buffer_store_dword v8, v9, s[32:35], s61 offen sc1
    s_branch L_he13
L_hf13:
    buffer_store_dword v8, v9, s[32:35], s61 offen
L_he13:
    s_mov_b64 exec, -1
    s_add_u32 s71, s71, 4096
    buffer_load_dwordx4 a[96:99], v4, s[32:35], s71 offen offset:0
    buffer_load_dwordx4 a[100:103], v4, s[32:35], s71 offen offset:1024
    buffer_load_dwordx4 a[104:107], v4, s[32:35], s71 offen offset:2048
    s_xor_b32 s71, s63, 1
    s_lshl_b32 s72, s69, 2
    s_add_u32 s71, s71, s72
    s_add_u32 s71, s71, 0
    s_mul_i32 s71, s71, 48
    s_mov_b32 s72, s79
    s_add_u32 s71, s71, s72
    s_lshl_b32 s71, s71, 10
    s_add_u32 s71, s71, 5242880
    buffer_load_dwordx4 a[108:111], v4, s[32:35], s71 offen offset:0
    buffer_load_dwordx4 a[112:115], v4, s[32:35], s71 offen offset:1024
    buffer_load_dwordx4 a[116:119], v4, s[32:35], s71 offen offset:2048
    buffer_load_dwordx4 a[120:123], v4, s[32:35], s71 offen offset:3072
    s_add_u32 s71, s71, 4096
    buffer_load_dwordx4 a[124:127], v4, s[32:35], s71 offen offset:0
    buffer_load_dword v6, v7, s[32:35], s77 offen sc1
    buffer_load_dwordx4 a[128:131], v4, s[32:35], s71 offen offset:1024
    buffer_load_dwordx4 a[132:135], v4, s[32:35], s71 offen offset:2048
    buffer_load_dwordx4 a[136:139], v4, s[32:35], s71 offen offset:3072
    s_add_u32 s71, s71, 4096
    buffer_load_dwordx4 a[140:143], v4, s[32:35], s71 offen offset:0
    buffer_load_dwordx4 a[144:147], v4, s[32:35], s71 offen offset:1024
    buffer_load_dwordx4 a[148:151], v4, s[32:35], s71 offen offset:2048
    s_xor_b32 s71, s64, 1
    s_mul_i32 s71, s71, 6144
    s_add_u32 s71, s71, 0
    v_add_u32 v204, s71, v4
    s_xor_b32 s71, s64, 2
    s_mul_i32 s71, s71, 6144
    s_add_u32 s71, s71, 2048
    v_add_u32 v205, s71, v4
    s_xor_b32 s71, s64, 3
    s_mul_i32 s71, s71, 6144
    s_add_u32 s71, s71, 4096
    v_add_u32 v206, s71, v4
    s_mul_i32 s71, s64, 6144
    s_add_u32 s71, s71, 0
    v_add_u32 v207, s71, v4
    v_lshlrev_b32 v27, 10, v2
    v_lshl_add_u32 v27, v3, 3, v27
    s_waitcnt vmcnt(6)
    s_nop 3
    s_mov_b32 s78, 0
    s_add_u32 s74, s76, 6
L_wait14:
    v_subrev_u32 v6, s74, v6
    v_cmp_lt_u32 vcc, 15, v6
    s_nop 1
    s_and_b64 vcc, vcc, -1
    s_cbranch_scc0 L_go14
    buffer_load_dword v6, v7, s[32:35], s77 offen sc1
    s_waitcnt vmcnt(0)
    s_add_u32 s78, s78, 1
    s_cmp_lt_u32 s78, 0x40000
    s_cbranch_scc1 L_wait14
L_go14:
    s_nop 1
    v_mfma_f32_16x16x32_bf16 v[32:35], a[192:195], a[64:67], 0
    v_mfma_f32_16x16x32_bf16 v[36:39], a[196:199], a[64:67], 0
    s_xor_b32 s71, s63, 0
    s_lshl_b32 s72, s69, 2
    s_add_u32 s71, s71, s72
    s_add_u32 s71, s71, 2
    s_mul_i32 s71, s71, 48
    s_mov_b32 s72, s79
    s_add_u32 s71, s71, s72
    s_lshl_b32 s71, s71, 10
    s_add_u32 s71, s71, 5242880
    buffer_load_dwordx4 a[152:155], v4, s[32:35], s71 offen offset:0
    v_mfma_f32_16x16x32_bf16 v[40:43], a[200:203], a[64:67], 0
    v_mfma_f32_16x16x32_bf16 v[44:47], a[204:207], a[64:67], 0
    v_mfma_f32_16x16x32_bf16 v[32:35], a[208:211], a[68:71], v[32:35]
    v_mfma_f32_16x16x32_bf16 v[36:39], a[212:215], a[68:71], v[36:39]
    buffer_load_dwordx4 a[156:159], v4, s[32:35], s71 offen offset:1024
    v_mfma_f32_16x16x32_bf16 v[40:43], a[216:219], a[68:71], v[40:43]
    v_mfma_f32_16x16x32_bf16 v[44:47], a[220:223], a[68:71], v[44:47]
    v_mfma_f32_16x16x32_bf16 v[32:35], a[224:227], a[72:75], v[32:35]
    v_mfma_f32_16x16x32_bf16 v[36:39], a[228:231], a[72:75], v[36:39]
    buffer_load_dwordx4 a[160:163], v4, s[32:35], s71 offen offset:2048
    v_mfma_f32_16x16x32_bf16 v[40:43], a[232:235], a[72:75], v[40:43]
    v_mfma_f32_16x16x32_bf16 v[44:47], a[236:239], a[72:75], v[44:47]
    v_mfma_f32_16x16x32_bf16 v[32:35], a[240:243], a[76:79], v[32:35]
    v_mfma_f32_16x16x32_bf16 v[36:39], a[244:247], a[76:79], v[36:39]
    buffer_load_dwordx4 a[164:167], v4, s[32:35], s71 offen offset:3072
    v_mfma_f32_16x16x32_bf16 v[40:43], a[248:251], a[76:79], v[40:43]
    v_mfma_f32_16x16x32_bf16 v[44:47], a[252:255], a[76:79], v[44:47]
    v_mfma_f32_16x16x32_bf16 v[32:35], v[208:211], a[80:83], v[32:35]
    v_mfma_f32_16x16x32_bf16 v[36:39], v[212:215], a[80:83], v[36:39]
    s_add_u32 s71, s71, 4096
    buffer_load_dwordx4 a[168:171], v4, s[32:35], s71 offen offset:0
    v_mfma_f32_16x16x32_bf16 v[40:43], v[216:219], a[80:83], v[40:43]
    v_mfma_f32_16x16x32_bf16 v[44:47], v[220:223], a[80:83], v[44:47]
    v_mfma_f32_16x16x32_bf16 v[32:35], v[224:227], a[84:87], v[32:35]
    v_mfma_f32_16x16x32_bf16 v[36:39], v[228:231], a[84:87], v[36:39]
    buffer_load_dwordx4 a[172:175], v4, s[32:35], s71 offen offset:1024
    v_mfma_f32_16x16x32_bf16 v[40:43], v[232:235], a[84:87], v[40:43]
    v_mfma_f32_16x16x32_bf16 v[44:47], v[236:239], a[84:87], v[44:47]
    v_mfma_f32_16x16x32_bf16 v[32:35], v[240:243], a[88:91], v[32:35]
    v_mfma_f32_16x16x32_bf16 v[36:39], v[244:247], a[88:91], v[36:39]
    buffer_load_dwordx4 a[176:179], v4, s[32:35], s71 offen offset:2048
    v_mfma_f32_16x16x32_bf16 v[40:43], v[248:251], a[88:91], v[40:43]
    v_mfma_f32_16x16x32_bf16 v[44:47], v[252:255], a[88:91], v[44:47]
    v_mfma_f32_16x16x32_bf16 v[32:35], a[0:3], a[92:95], v[32:35]
    v_mfma_f32_16x16x32_bf16 v[36:39], a[4:7], a[92:95], v[36:39]
    buffer_load_dwordx4 a[180:183], v4, s[32:35], s71 offen offset:3072
    v_mfma_f32_16x16x32_bf16 v[40:43], a[8:11], a[92:95], v[40:43]
    v_mfma_f32_16x16x32_bf16 v[44:47], a[12:15], a[92:95], v[44:47]
    v_mfma_f32_16x16x32_bf16 v[32:35], a[16:19], a[96:99], v[32:35]
    v_mfma_f32_16x16x32_bf16 v[36:39], a[20:23], a[96:99], v[36:39]
    s_add_u32 s71, s71, 4096
    buffer_load_dwordx4 a[184:187], v4, s[32:35], s71 offen offset:0
    v_mfma_f32_16x16x32_bf16 v[40:43], a[24:27], a[96:99], v[40:43]
    v_mfma_f32_16x16x32_bf16 v[44:47], a[28:31], a[96:99], v[44:47]
    v_mfma_f32_16x16x32_bf16 v[32:35], a[32:35], a[100:103], v[32:35]
    v_mfma_f32_16x16x32_bf16 v[36:39], a[36:39], a[100:103], v[36:39]
    buffer_load_dwordx4 a[188:191], v4, s[32:35], s71 offen offset:1024
    v_mfma_f32_16x16x32_bf16 v[40:43], a[40:43], a[100:103], v[40:43]
    v_mfma_f32_16x16x32_bf16 v[44:47], a[44:47], a[100:103], v[44:47]
    v_mfma_f32_16x16x32_bf16 v[32:35], a[48:51], a[104:107], v[32:35]
    v_mfma_f32_16x16x32_bf16 v[36:39], a[52:55], a[104:107], v[36:39]
    buffer_load_dwordx4 v[128:131], v4, s[32:35], s71 offen offset:2048
    v_mfma_f32_16x16x32_bf16 v[40:43], a[56:59], a[104:107], v[40:43]
    v_mfma_f32_16x16x32_bf16 v[44:47], a[60:63], a[104:107], v[44:47]
    v_mfma_f32_16x16x32_bf16 v[48:51], a[192:195], a[108:111], 0
    v_mfma_f32_16x16x32_bf16 v[52:55], a[196:199], a[108:111], 0
    s_xor_b32 s71, s63, 1
    s_lshl_b32 s72, s69, 2
    s_add_u32 s71, s71, s72
    s_add_u32 s71, s71, 2
    s_mul_i32 s71, s71, 48
    s_mov_b32 s72, s79
    s_add_u32 s71, s71, s72
    s_lshl_b32 s71, s71, 10
    s_add_u32 s71, s71, 5242880
    buffer_load_dwordx4 v[132:135], v4, s[32:35], s71 offen offset:0
    v_mfma_f32_16x16x32_bf16 v[56:59], a[200:203], a[108:111], 0
    v_mfma_f32_16x16x32_bf16 v[60:63], a[204:207], a[108:111], 0
    v_mfma_f32_16x16x32_bf16 v[48:51], a[208:211], a[112:115], v[48:51]
    v_mfma_f32_16x16x32_bf16 v[52:55], a[212:215], a[112:115], v[52:55]
    buffer_load_dwordx4 v[136:139], v4, s[32:35], s71 offen offset:1024
    v_mfma_f32_16x16x32_bf16 v[56:59], a[216:219], a[112:115], v[56:59]
    v_mfma_f32_16x16x32_bf16 v[60:63], a[220:223], a[112:115], v[60:63]
    ds_write_b128 v204, v[40:43] offset:0
    ds_write_b128 v204, v[44:47] offset:1024
    v_mfma_f32_16x16x32_bf16 v[48:51], a[224:227], a[116:119], v[48:51]
    v_mfma_f32_16x16x32_bf16 v[52:55], a[228:231], a[116:119], v[52:55]
    buffer_load_dwordx4 v[140:143], v4, s[32:35], s71 offen offset:2048
    v_mfma_f32_16x16x32_bf16 v[56:59], a[232:235], a[116:119], v[56:59]
    v_mfma_f32_16x16x32_bf16 v[60:63], a[236:239], a[116:119], v[60:63]
    v_mfma_f32_16x16x32_bf16 v[48:51], a[240:243], a[120:123], v[48:51]
    v_mfma_f32_16x16x32_bf16 v[52:55], a[244:247], a[120:123], v[52:55]
    buffer_load_dwordx4 v[144:147], v4, s[32:35], s71 offen offset:3072
    v_mfma_f32_16x16x32_bf16 v[56:59], a[248:251], a[120:123], v[56:59]
    v_mfma_f32_16x16x32_bf16 v[60:63], a[252:255], a[120:123], v[60:63]
    v_mfma_f32_16x16x32_bf16 v[48:51], v[208:211], a[124:127], v[48:51]
    v_mfma_f32_16x16x32_bf16 v[52:55], v[212:215], a[124:127], v[52:55]
    s_add_u32 s71, s71, 4096
    buffer_load_dwordx4 v[148:151], v4, s[32:35], s71 offen offset:0
    v_mfma_f32_16x16x32_bf16 v[56:59], v[216:219], a[124:127], v[56:59]
    v_mfma_f32_16x16x32_bf16 v[60:63], v[220:223], a[124:127], v[60:63]
    s_waitcnt vmcnt(21)
    v_mfma_f32_16x16x32_bf16 v[48:51], v[224:227], a[128:131], v[48:51]
    v_mfma_f32_16x16x32_bf16 v[52:55], v[228:231], a[128:131], v[52:55]
    buffer_load_dwordx4 v[152:155], v4, s[32:35], s71 offen offset:1024
    v_mfma_f32_16x16x32_bf16 v[56:59], v[232:235], a[128:131], v[56:59]
    v_mfma_f32_16x16x32_bf16 v[60:63], v[236:239], a[128:131], v[60:63]
    s_waitcnt vmcnt(21)
    v_mfma_f32_16x16x32_bf16 v[48:51], v[240:243], a[132:135], v[48:51]
    v_mfma_f32_16x16x32_bf16 v[52:55], v[244:247], a[132:135], v[52:55]
    buffer_load_dwordx4 v[156:159], v4, s[32:35], s71 offen offset:2048
    v_mfma_f32_16x16x32_bf16 v[56:59], v[248:251], a[132:135], v[56:59]
    v_mfma_f32_16x16x32_bf16 v[60:63], v[252:255], a[132:135], v[60:63]
    s_waitcnt vmcnt(21)
    v_mfma_f32_16x16x32_bf16 v[48:51], a[0:3], a[136:139], v[48:51]
    v_mfma_f32_16x16x32_bf16 v[52:55], a[4:7], a[136:139], v[52:55]
    buffer_load_dwordx4 v[160:163], v4, s[32:35], s71 offen offset:3072
    v_mfma_f32_16x16x32_bf16 v[56:59], a[8:11], a[136:139], v[56:59]
    v_mfma_f32_16x16x32_bf16 v[60:63], a[12:15], a[136:139], v[60:63]
    s_waitcnt vmcnt(21)
    v_mfma_f32_16x16x32_bf16 v[48:51], a[16:19], a[140:143], v[48:51]
    v_mfma_f32_16x16x32_bf16 v[52:55], a[20:23], a[140:143], v[52:55]
    s_add_u32 s71, s71, 4096
    buffer_load_dwordx4 v[164:167], v4, s[32:35], s71 offen offset:0
    v_mfma_f32_16x16x32_bf16 v[56:59], a[24:27], a[140:143], v[56:59]
    v_mfma_f32_16x16x32_bf16 v[60:63], a[28:31], a[140:143], v[60:63]
    s_waitcnt vmcnt(21)
    v_mfma_f32_16x16x32_bf16 v[48:51], a[32:35], a[144:147], v[48:51]
    v_mfma_f32_16x16x32_bf16 v[52:55], a[36:39], a[144:147], v[52:55]
    buffer_load_dwordx4 v[168:171], v4, s[32:35], s71 offen offset:1024
    v_mfma_f32_16x16x32_bf16 v[56:59], a[40:43], a[144:147], v[56:59]
    v_mfma_f32_16x16x32_bf16 v[60:63], a[44:47], a[144:147], v[60:63]
    s_waitcnt vmcnt(21)
    v_mfma_f32_16x16x32_bf16 v[48:51], a[48:51], a[148:151], v[48:51]
    v_mfma_f32_16x16x32_bf16 v[52:55], a[52:55], a[148:151], v[52:55]
    buffer_load_dwordx4 v[172:175], v4, s[32:35], s71 offen offset:2048
    v_mfma_f32_16x16x32_bf16 v[56:59], a[56:59], a[148:151], v[56:59]
    v_mfma_f32_16x16x32_bf16 v[60:63], a[60:63], a[148:151], v[60:63]
    s_nop 3
    ds_write_b128 v205, v[48:51] offset:0
    ds_write_b128 v205, v[52:55] offset:1024
    s_nop 0
    ds_write_b128 v206, v[56:59] offset:0
    ds_write_b128 v206, v[60:63] offset:1024
    s_waitcnt lgkmcnt(0)
    s_barrier
    ds_read_b128 v[96:99], v207 offset:0
    ds_read_b128 v[100:103], v207 offset:1024
    ds_read_b128 v[104:107], v207 offset:2048
    ds_read_b128 v[108:111], v207 offset:3072
    ds_read_b128 v[112:115], v207 offset:4096
    ds_read_b128 v[116:119], v207 offset:5120
    v_lshlrev_b32 v120, 16, v18
    v_and_b32 v121, 0xffff0000, v18
    v_lshlrev_b32 v122, 16, v19
    v_and_b32 v123, 0xffff0000, v19
    v_lshlrev_b32 v124, 16, v20
    v_and_b32 v125, 0xffff0000, v20
    v_lshlrev_b32 v126, 16, v21
    v_and_b32 v127, 0xffff0000, v21
    v_pk_add_f32 v[32:33], v[32:33], v[120:121]
    v_pk_add_f32 v[34:35], v[34:35], v[122:123]
    v_pk_add_f32 v[36:37], v[36:37], v[124:125]
    v_pk_add_f32 v[38:39], v[38:39], v[126:127]
    s_waitcnt lgkmcnt(4)
    v_pk_add_f32 v[32:33], v[32:33], v[96:97]
    v_pk_add_f32 v[34:35], v[34:35], v[98:99]
    v_pk_add_f32 v[36:37], v[36:37], v[100:101]
    v_pk_add_f32 v[38:39], v[38:39], v[102:103]
    s_waitcnt lgkmcnt(2)
    v_pk_add_f32 v[32:33], v[32:33], v[104:105]
    v_pk_add_f32 v[34:35], v[34:35], v[106:107]
    v_pk_add_f32 v[36:37], v[36:37], v[108:109]
    v_pk_add_f32 v[38:39], v[38:39], v[110:111]
    s_waitcnt lgkmcnt(0)
    v_pk_add_f32 v[32:33], v[32:33], v[112:113]
    v_pk_add_f32 v[34:35], v[34:35], v[114:115]
    v_pk_add_f32 v[36:37], v[36:37], v[116:117]
    v_pk_add_f32 v[38:39], v[38:39], v[118:119]
    v_cvt_pk_bf16_f32 v18, v32, v33
    v_cvt_pk_bf16_f32 v19, v34, v35
    v_cvt_pk_bf16_f32 v20, v36, v37
    v_cvt_pk_bf16_f32 v21, v38, v39
    s_lshl_b32 s73, s69, 16
    s_lshl_b32 s72, s63, 14
    s_add_u32 s73, s73, s72
    s_lshl_b32 s72, s68, 7
    s_add_u32 s73, s73, s72
    s_lshl_b32 s72, s62, 6
    s_add_u32 s73, s73, s72
    s_add_u32 s73, s73, 0
    buffer_store_dwordx2 v[18:19], v27, s[28:31], s73 offen offset:0
    buffer_store_dwordx2 v[20:21], v27, s[28:31], s73 offen offset:32
    s_waitcnt vmcnt(23)
    v_mfma_f32_16x16x32_bf16 v[64:67], a[192:195], a[152:155], 0
    v_mfma_f32_16x16x32_bf16 v[68:71], a[196:199], a[152:155], 0
    v_mfma_f32_16x16x32_bf16 v[72:75], a[200:203], a[152:155], 0
    v_mfma_f32_16x16x32_bf16 v[76:79], a[204:207], a[152:155], 0
    s_waitcnt vmcnt(22)
    v_mfma_f32_16x16x32_bf16 v[64:67], a[208:211], a[156:159], v[64:67]
    v_mfma_f32_16x16x32_bf16 v[68:71], a[212:215], a[156:159], v[68:71]
    v_mfma_f32_16x16x32_bf16 v[72:75], a[216:219], a[156:159], v[72:75]
    v_mfma_f32_16x16x32_bf16 v[76:79], a[220:223], a[156:159], v[76:79]
    s_waitcnt vmcnt(21)
    v_mfma_f32_16x16x32_bf16 v[64:67], a[224:227], a[160:163], v[64:67]
    v_mfma_f32_16x16x32_bf16 v[68:71], a[228:231], a[160:163], v[68:71]
    v_mfma_f32_16x16x32_bf16 v[72:75], a[232:235], a[160:163], v[72:75]
    v_mfma_f32_16x16x32_bf16 v[76:79], a[236:239], a[160:163], v[76:79]
    s_waitcnt vmcnt(20)
    v_mfma_f32_16x16x32_bf16 v[64:67], a[240:243], a[164:167], v[64:67]
    v_mfma_f32_16x16x32_bf16 v[68:71], a[244:247], a[164:167], v[68:71]
    v_mfma_f32_16x16x32_bf16 v[72:75], a[248:251], a[164:167], v[72:75]
    v_mfma_f32_16x16x32_bf16 v[76:79], a[252:255], a[164:167], v[76:79]
    s_waitcnt vmcnt(19)
    v_mfma_f32_16x16x32_bf16 v[64:67], v[208:211], a[168:171], v[64:67]
    v_mfma_f32_16x16x32_bf16 v[68:71], v[212:215], a[168:171], v[68:71]
    v_mfma_f32_16x16x32_bf16 v[72:75], v[216:219], a[168:171], v[72:75]
    v_mfma_f32_16x16x32_bf16 v[76:79], v[220:223], a[168:171], v[76:79]
    s_waitcnt vmcnt(18)
    v_mfma_f32_16x16x32_bf16 v[64:67], v[224:227], a[172:175], v[64:67]
    v_mfma_f32_16x16x32_bf16 v[68:71], v[228:231], a[172:175], v[68:71]
    v_mfma_f32_16x16x32_bf16 v[72:75], v[232:235], a[172:175], v[72:75]
    v_mfma_f32_16x16x32_bf16 v[76:79], v[236:239], a[172:175], v[76:79]
    s_waitcnt vmcnt(17)
    v_mfma_f32_16x16x32_bf16 v[64:67], v[240:243], a[176:179], v[64:67]
    v_mfma_f32_16x16x32_bf16 v[68:71], v[244:247], a[176:179], v[68:71]
    v_mfma_f32_16x16x32_bf16 v[72:75], v[248:251], a[176:179], v[72:75]
    v_mfma_f32_16x16x32_bf16 v[76:79], v[252:255], a[176:179], v[76:79]
    s_waitcnt vmcnt(16)
    v_mfma_f32_16x16x32_bf16 v[64:67], a[0:3], a[180:183], v[64:67]
    v_mfma_f32_16x16x32_bf16 v[68:71], a[4:7], a[180:183], v[68:71]
    v_mfma_f32_16x16x32_bf16 v[72:75], a[8:11], a[180:183], v[72:75]
    v_mfma_f32_16x16x32_bf16 v[76:79], a[12:15], a[180:183], v[76:79]
    s_waitcnt vmcnt(15)
    v_mfma_f32_16x16x32_bf16 v[64:67], a[16:19], a[184:187], v[64:67]
    v_mfma_f32_16x16x32_bf16 v[68:71], a[20:23], a[184:187], v[68:71]
    v_mfma_f32_16x16x32_bf16 v[72:75], a[24:27], a[184:187], v[72:75]
    v_mfma_f32_16x16x32_bf16 v[76:79], a[28:31], a[184:187], v[76:79]
    s_waitcnt vmcnt(14)
    v_mfma_f32_16x16x32_bf16 v[64:67], a[32:35], a[188:191], v[64:67]
    v_mfma_f32_16x16x32_bf16 v[68:71], a[36:39], a[188:191], v[68:71]
    v_mfma_f32_16x16x32_bf16 v[72:75], a[40:43], a[188:191], v[72:75]
    v_mfma_f32_16x16x32_bf16 v[76:79], a[44:47], a[188:191], v[76:79]
    s_waitcnt vmcnt(13)
    v_mfma_f32_16x16x32_bf16 v[64:67], a[48:51], v[128:131], v[64:67]
    v_mfma_f32_16x16x32_bf16 v[68:71], a[52:55], v[128:131], v[68:71]
    v_mfma_f32_16x16x32_bf16 v[72:75], a[56:59], v[128:131], v[72:75]
    v_mfma_f32_16x16x32_bf16 v[76:79], a[60:63], v[128:131], v[76:79]
    s_waitcnt vmcnt(12)
    v_mfma_f32_16x16x32_bf16 v[80:83], a[192:195], v[132:135], 0
    v_mfma_f32_16x16x32_bf16 v[84:87], a[196:199], v[132:135], 0
    v_mfma_f32_16x16x32_bf16 v[88:91], a[200:203], v[132:135], 0
    v_mfma_f32_16x16x32_bf16 v[92:95], a[204:207], v[132:135], 0
    s_waitcnt vmcnt(11)
    v_mfma_f32_16x16x32_bf16 v[80:83], a[208:211], v[136:139], v[80:83]
    v_mfma_f32_16x16x32_bf16 v[84:87], a[212:215], v[136:139], v[84:87]
    v_mfma_f32_16x16x32_bf16 v[88:91], a[216:219], v[136:139], v[88:91]
    v_mfma_f32_16x16x32_bf16 v[92:95], a[220:223], v[136:139], v[92:95]
    ds_write_b128 v204, v[72:75] offset:24576
    ds_write_b128 v204, v[76:79] offset:25600
    s_waitcnt vmcnt(10)
    v_mfma_f32_16x16x32_bf16 v[80:83], a[224:227], v[140:143], v[80:83]
    v_mfma_f32_16x16x32_bf16 v[84:87], a[228:231], v[140:143], v[84:87]
    v_mfma_f32_16x16x32_bf16 v[88:91], a[232:235], v[140:143], v[88:91]
    v_mfma_f32_16x16x32_bf16 v[92:95], a[236:239], v[140:143], v[92:95]
    s_waitcnt vmcnt(9)
    v_mfma_f32_16x16x32_bf16 v[80:83], a[240:243], v[144:147], v[80:83]
    v_mfma_f32_16x16x32_bf16 v[84:87], a[244:247], v[144:147], v[84:87]
    v_mfma_f32_16x16x32_bf16 v[88:91], a[248:251], v[144:147], v[88:91]
    v_mfma_f32_16x16x32_bf16 v[92:95], a[252:255], v[144:147], v[92:95]
    s_waitcnt vmcnt(8)
    v_mfma_f32_16x16x32_bf16 v[80:83], v[208:211], v[148:151], v[80:83]
    v_mfma_f32_16x16x32_bf16 v[84:87], v[212:215], v[148:151], v[84:87]
    v_mfma_f32_16x16x32_bf16 v[88:91], v[216:219], v[148:151], v[88:91]
    v_mfma_f32_16x16x32_bf16 v[92:95], v[220:223], v[148:151], v[92:95]
    s_waitcnt vmcnt(7)
    v_mfma_f32_16x16x32_bf16 v[80:83], v[224:227], v[152:155], v[80:83]
    v_mfma_f32_16x16x32_bf16 v[84:87], v[228:231], v[152:155], v[84:87]
    v_mfma_f32_16x16x32_bf16 v[88:91], v[232:235], v[152:155], v[88:91]
    v_mfma_f32_16x16x32_bf16 v[92:95], v[236:239], v[152:155], v[92:95]
    s_waitcnt vmcnt(6)
    v_mfma_f32_16x16x32_bf16 v[80:83], v[240:243], v[156:159], v[80:83]
    v_mfma_f32_16x16x32_bf16 v[84:87], v[244:247], v[156:159], v[84:87]
    v_mfma_f32_16x16x32_bf16 v[88:91], v[248:251], v[156:159], v[88:91]
    v_mfma_f32_16x16x32_bf16 v[92:95], v[252:255], v[156:159], v[92:95]
    s_waitcnt vmcnt(5)
    v_mfma_f32_16x16x32_bf16 v[80:83], a[0:3], v[160:163], v[80:83]
    v_mfma_f32_16x16x32_bf16 v[84:87], a[4:7], v[160:163], v[84:87]
    v_mfma_f32_16x16x32_bf16 v[88:91], a[8:11], v[160:163], v[88:91]
    v_mfma_f32_16x16x32_bf16 v[92:95], a[12:15], v[160:163], v[92:95]
    s_waitcnt vmcnt(4)
    v_mfma_f32_16x16x32_bf16 v[80:83], a[16:19], v[164:167], v[80:83]
    v_mfma_f32_16x16x32_bf16 v[84:87], a[20:23], v[164:167], v[84:87]
    v_mfma_f32_16x16x32_bf16 v[88:91], a[24:27], v[164:167], v[88:91]
    v_mfma_f32_16x16x32_bf16 v[92:95], a[28:31], v[164:167], v[92:95]
    s_waitcnt vmcnt(3)
    v_mfma_f32_16x16x32_bf16 v[80:83], a[32:35], v[168:171], v[80:83]
    v_mfma_f32_16x16x32_bf16 v[84:87], a[36:39], v[168:171], v[84:87]
    v_mfma_f32_16x16x32_bf16 v[88:91], a[40:43], v[168:171], v[88:91]
    v_mfma_f32_16x16x32_bf16 v[92:95], a[44:47], v[168:171], v[92:95]
    s_waitcnt vmcnt(2)
    v_mfma_f32_16x16x32_bf16 v[80:83], a[48:51], v[172:175], v[80:83]
    v_mfma_f32_16x16x32_bf16 v[84:87], a[52:55], v[172:175], v[84:87]
    v_mfma_f32_16x16x32_bf16 v[88:91], a[56:59], v[172:175], v[88:91]
    v_mfma_f32_16x16x32_bf16 v[92:95], a[60:63], v[172:175], v[92:95]
    s_nop 4
    ds_write_b128 v205, v[80:83] offset:24576
    ds_write_b128 v205, v[84:87] offset:25600
    ds_write_b128 v206, v[88:91] offset:24576
    ds_write_b128 v206, v[92:95] offset:25600
    s_waitcnt lgkmcnt(0)
    s_barrier
    ds_read_b128 v[96:99], v207 offset:24576
    ds_read_b128 v[100:103], v207 offset:25600
    ds_read_b128 v[104:107], v207 offset:26624
    ds_read_b128 v[108:111], v207 offset:27648
    ds_read_b128 v[112:115], v207 offset:28672
    ds_read_b128 v[116:119], v207 offset:29696
    v_lshlrev_b32 v120, 16, v22
    v_and_b32 v121, 0xffff0000, v22
    v_lshlrev_b32 v122, 16, v23
    v_and_b32 v123, 0xffff0000, v23
    v_lshlrev_b32 v124, 16, v24
    v_and_b32 v125, 0xffff0000, v24
    v_lshlrev_b32 v126, 16, v25
    v_and_b32 v127, 0xffff0000, v25
    v_pk_add_f32 v[64:65], v[64:65], v[120:121]
    v_pk_add_f32 v[66:67], v[66:67], v[122:123]
    v_pk_add_f32 v[68:69], v[68:69], v[124:125]
    v_pk_add_f32 v[70:71], v[70:71], v[126:127]
    s_waitcnt lgkmcnt(4)
    v_pk_add_f32 v[64:65], v[64:65], v[96:97]
    v_pk_add_f32 v[66:67], v[66:67], v[98:99]
    v_pk_add_f32 v[68:69], v[68:69], v[100:101]
    v_pk_add_f32 v[70:71], v[70:71], v[102:103]
    s_waitcnt lgkmcnt(2)
    v_pk_add_f32 v[64:65], v[64:65], v[104:105]
    v_pk_add_f32 v[66:67], v[66:67], v[106:107]
    v_pk_add_f32 v[68:69], v[68:69], v[108:109]
    v_pk_add_f32 v[70:71], v[70:71], v[110:111]
    s_waitcnt lgkmcnt(0)
    v_pk_add_f32 v[64:65], v[64:65], v[112:113]
    v_pk_add_f32 v[66:67], v[66:67], v[114:115]
    v_pk_add_f32 v[68:69], v[68:69], v[116:117]
    v_pk_add_f32 v[70:71], v[70:71], v[118:119]
    v_cvt_pk_bf16_f32 v22, v64, v65
    v_cvt_pk_bf16_f32 v23, v66, v67
    v_cvt_pk_bf16_f32 v24, v68, v69
    v_cvt_pk_bf16_f32 v25, v70, v71
    s_lshl_b32 s73, s69, 16
    s_lshl_b32 s72, s63, 14
    s_add_u32 s73, s73, s72
    s_lshl_b32 s72, s68, 7
    s_add_u32 s73, s73, s72
    s_lshl_b32 s72, s62, 6
    s_add_u32 s73, s73, s72
    s_add_u32 s73, s73, 32768
    buffer_store_dwordx2 v[22:23], v27, s[28:31], s73 offen offset:0
    buffer_store_dwordx2 v[24:25], v27, s[28:31], s73 offen offset:32
L_done:
    s_endpgm
.section .rodata,"a"
.p2align 6
.amdhsa_kernel sequential_preLN__sliding_local_dilated__glu_gated_reglu__prompt_kernel
  .amdhsa_next_free_vgpr 512
  .amdhsa_next_free_sgpr 102
  .amdhsa_accum_offset 256
  .amdhsa_group_segment_fixed_size 0
  .amdhsa_kernarg_size 80
  .amdhsa_user_sgpr_count 2
  .amdhsa_user_sgpr_kernarg_segment_ptr 1
  .amdhsa_system_sgpr_workgroup_id_x 1
.end_amdhsa_kernel
```
